```python
import torch

def _softmax(x, axis=-1):
    return torch.softmax(x, dim=axis)
def _gelu(x):
    return torch.nn.functional.gelu(x, approximate="tanh")
def _silu(x):
    return torch.nn.functional.silu(x)
def _sigmoid(x):
    return torch.sigmoid(x)
def _layernorm(x, axis=-1, eps=1e-5):
    m = x.mean(dim=axis, keepdim=True)
    v = x.var(dim=axis, keepdim=True, unbiased=False)
    return (x - m) / torch.sqrt(v + eps)
def _scatter_add(tgt, idx, src, axis=0):
    return tgt.clone().index_add_(axis, idx, src)
def _segment_sum(src, seg, n):
    out = torch.zeros((n,) + src.shape[1:], dtype=src.dtype)
    return out.index_add_(0, seg, src)
def _pad(x, pw):
    flat = tuple(v for pair in reversed(pw) for v in pair)
    return torch.nn.functional.pad(x, flat)

kernel_name = 'standalone__modern_conv_block_convnext__vision'

def setup_inputs():

    _w = (lambda a: (lambda t: t.to(torch.bfloat16) if t.is_floating_point() else t)(torch.as_tensor(a)))
    H = W = 224
    C = 192
    K = 3
    return {
        "x": _w((lambda *s: torch.randn(*s, dtype=torch.bfloat16) * 0.05)(1, H, W, C)),
        "dw": _w((lambda *s: torch.randn(*s, dtype=torch.bfloat16) * 0.05)(K, K, C)),
        "w1": _w((lambda *s: torch.randn(*s, dtype=torch.bfloat16) * 0.05)(C, 4 * C)),
        "b1": _w((lambda *s: torch.randn(*s, dtype=torch.bfloat16) * 0.2)(4 * C)),
        "w2": _w((lambda *s: torch.randn(*s, dtype=torch.bfloat16) * 0.05)(4 * C, C)),
        "b2": _w((lambda *s: torch.randn(*s, dtype=torch.bfloat16) * 0.4)(C)),
        "gamma": _w((lambda *s: torch.randn(*s, dtype=torch.bfloat16) * 0.05)(C)),
    }

def reference(x, dw, w1, b1, w2, b2, gamma):
    B, H, W, C = x.shape
    K = dw.shape[0]
    pad = K // 2
    xp = _pad(x, ((0,0),(pad,pad),(pad,pad),(0,0)))
    out = torch.zeros_like(x)
    for i in range(K):
        for j in range(K):
            out = out + xp[:, i:i+H, j:j+W, :] * dw[i, j][None, None, None, :]
    h = _layernorm(out, axis=-1)
    h = torch.einsum('bhwc,ce->bhwe', h, w1) + b1
    h = _gelu(h)
    h = torch.einsum('bhwe,ec->bhwc', h, w2) + b2
    return x + gamma[None, None, None, :] * h
```

```asm
; @launch grid=(256,1,1) block=(512,1,1) lds=163840
.amdgcn_target "amdgcn-amd-amdhsa--gfx950"
.text
.globl standalone__modern_conv_block_convnext__vision_kernel
.p2align 8
.type standalone__modern_conv_block_convnext__vision_kernel,@function
standalone__modern_conv_block_convnext__vision_kernel:
    s_load_dwordx16 s[40:55], s[0:1], 0
    s_and_b32 s64, s2, 56
    s_cbranch_scc1 L_nopf
    s_getpc_b64 s[62:63]
    v_lshlrev_b32 v1, 7, v0
    v_min_u32 v1, L_code_end-standalone__modern_conv_block_convnext__vision_kernel-128, v1
    v_mov_b32 v3, s63
    v_add_co_u32 v2, vcc, s62, v1
    s_nop 1
    v_addc_co_u32 v3, vcc, 0, v3, vcc
    global_load_dword v255, v[2:3], off
L_nopf:
    s_cmp_ge_u32 s2, 256
    s_cbranch_scc1 L_exit
    s_and_b32 s62, s2, 7
    s_lshr_b32 s63, s2, 3
    s_and_b32 s64, s2, 0xf9
    s_cmp_eq_u32 s64, 0xf9
    s_cbranch_scc1 L_exit
    s_mul_i32 s62, s62, 63
    s_add_u32 s62, s62, 1
    s_lshr_b32 s62, s62, 1
    s_add_u32 s62, s62, s63
    s_mul_i32 s64, s62, 4682
    s_lshr_b32 s64, s64, 16
    s_mul_i32 s4, s64, 815584
    s_add_u32 s6, s4, 815584
    s_lshr_b32 s4, s4, 16
    s_lshr_b32 s6, s6, 16
    s_sub_u32 s6, s6, s4
    s_mul_i32 s64, s64, 14
    s_sub_u32 s5, s62, s64
    s_lshl_b32 s5, s5, 4
    v_lshrrev_b32 v1, 6, v0
    v_mul_u32_u24 v2, 2731, v0
    v_readfirstlane_b32 s3, v1
    v_lshrrev_b32 v2, 16, v2
    v_bfe_u32 v3, v2, 1, 3
    v_xor_b32 v3, v3, v0
    v_lshlrev_b32 v3, 4, v3
    s_sub_u32 s64, s5, 1
    v_add_u32 v2, s64, v2
    s_mul_i32 s64, s64, 384
    v_add_u32 v3, s64, v3
    v_mov_b32 v124, 1073741824
    v_cmp_gt_u32 vcc, 224, v2
    s_mov_b32 s10, 19267584
    s_mov_b32 s11, 0x20000
    v_cndmask_b32 v113, v124, v3, vcc
    v_cmp_gt_u32 vcc, 432, v0
    s_sub_u32 s32, s4, 1
    s_mul_i32 s32, s32, 86016
    s_lshl_b32 s33, s3, 10
    s_add_u32 s33, s33, 49152
    s_mov_b64 s[38:39], vcc
    v_and_b32 v0, 63, v0
    v_lshlrev_b32 v114, 4, v0
    s_waitcnt lgkmcnt(0)
    s_mov_b32 s8, s40
    s_mov_b32 s9, s41
    s_cmp_eq_u32 s3, 7
    s_cbranch_scc1 L_nox0
    s_mov_b64 exec, s[38:39]
    s_add_u32 m0, s33, 0
    s_cmp_eq_u32 s4, 0
    s_cselect_b32 s62, 1073741824, s32
    buffer_load_dwordx4 v113, s[8:11], s62 offen lds
    s_add_u32 s32, s32, 86016
    s_add_u32 m0, s33, 6912
    s_nop 0
    buffer_load_dwordx4 v113, s[8:11], s32 offen lds
    s_add_u32 s32, s32, 86016
    s_add_u32 m0, s33, 13824
    s_nop 0
    buffer_load_dwordx4 v113, s[8:11], s32 offen lds
    s_add_u32 s32, s32, 86016
    s_add_u32 m0, s33, 20736
    s_nop 0
    buffer_load_dwordx4 v113, s[8:11], s32 offen lds
    s_add_u32 s32, s32, 86016
    s_mov_b64 exec, -1
    s_branch L_common
L_nox0:
    s_setprio 3
    s_mov_b32 s24, s42
    s_mov_b32 s25, s43
    s_mov_b32 s26, 3456
    s_mov_b32 s27, 0x20000
    s_mov_b32 m0, 147456
    v_lshlrev_b32 v129, 3, v0
    buffer_load_dwordx4 v114, s[24:27], 0 offen lds
    buffer_load_dwordx4 v114, s[24:27], 0 offen offset:1024 lds
    buffer_load_dwordx4 v114, s[24:27], 0 offen offset:2048 lds
    buffer_load_dwordx4 v114, s[24:27], 0 offen offset:3072 lds
    s_setprio 0
    s_mov_b32 s28, s46
    s_mov_b32 s29, s47
    s_mov_b32 s30, 1536
    s_mov_b32 s31, 0x20000
    s_mov_b32 s56, s50
    s_mov_b32 s57, s51
    s_mov_b32 s58, 384
    s_mov_b32 s59, 0x20000
    buffer_load_dwordx2 v[16:17], v129, s[28:31], 0 offen
    buffer_load_dwordx2 v[18:19], v129, s[28:31], 0 offen offset:512
    buffer_load_dwordx2 v[20:21], v129, s[28:31], 0 offen offset:1024
    buffer_load_dwordx2 v[22:23], v129, s[56:59], 0 offen
    s_mov_b32 s28, s52
    s_mov_b32 s29, s53
    s_mov_b32 s30, 384
    s_nop 0
    buffer_load_dwordx2 v[24:25], v129, s[28:31], 0 offen
L_common:
    s_mov_b32 s14, 19267584
    s_mov_b32 s15, 0x20000
    s_mov_b32 s18, 294912
    s_mov_b32 s19, 0x20000
    s_mov_b32 s22, 294912
    s_mov_b32 s23, 0x20000
    s_mov_b32 s16, s44
    s_mov_b32 s17, s45
    s_mov_b32 s20, s48
    s_mov_b32 s21, s49
    s_mov_b32 s12, s54
    s_mov_b32 s13, s55
    s_mov_b32 s60, 0x44ea44ea
    s_mov_b32 s7, 0x3c003c00
    v_mov_b32 v118, 0x4091afa4
    v_mov_b32 v119, 0x383ef424
    v_bfe_u32 v125, v0, 4, 1
    v_lshrrev_b32 v130, 5, v0
    v_bfe_u32 v126, v0, 2, 1
    v_sub_u32 v127, v125, v126
    v_bfe_u32 v126, v0, 3, 1
    v_and_b32 v128, 3, v0
    v_lshl_add_u32 v126, v126, 2, v128
    s_mul_i32 s64, s3, 48
    s_add_u32 s64, s64, 147456
    v_max_i32 v128, 0, v127
    v_mul_u32_u24 v128, 1152, v128
    v_add_u32 v107, s64, v128
    v_mul_u32_u24 v129, 384, v130
    v_add_u32 v105, v107, v129
    v_min_i32 v128, 0, v127
    v_add_u32 v128, 2, v128
    v_mul_u32_u24 v128, 1152, v128
    v_add_u32 v108, s64, v128
    v_add_u32 v106, v108, v129
    v_bfe_u32 v132, v0, 2, 3
    v_bfe_u32 v133, v0, 4, 1
    v_and_b32 v134, 3, v0
    v_lshrrev_b32 v135, 5, v0
    v_lshlrev_b32 v135, 6, v135
    v_xor_b32 v115, v134, v133
    v_lshl_add_u32 v115, v115, 4, v135
    v_mul_u32_u24 v136, 1536, v132
    v_add_u32 v115, v115, v136
    v_lshlrev_b32 v133, 1, v133
    v_xor_b32 v116, v134, v133
    v_lshl_add_u32 v116, v116, 4, v135
    v_mul_u32_u24 v136, 384, v132
    v_add_u32 v116, v116, v136
    v_mul_u32_u24 v132, 6912, v125
    v_add_u32 v132, 49152, v132
    v_and_b32 v133, 15, v0
    s_mul_i32 s64, s3, 3
    v_add_u32 v134, v130, v133
    v_mul_u32_u24 v135, 384, v134
    v_add_u32 v135, v135, v132
    v_bfe_u32 v134, v134, 1, 3
    s_add_u32 s62, s64, 0
    v_xor_b32 v100, s62, v134
    v_lshl_add_u32 v100, v100, 4, v135
    s_add_u32 s62, s64, 1
    v_xor_b32 v101, s62, v134
    v_lshl_add_u32 v101, v101, 4, v135
    s_add_u32 s62, s64, 2
    v_xor_b32 v102, s62, v134
    v_lshl_add_u32 v102, v102, 4, v135
    v_add_u32 v134, 2, v133
    v_mul_u32_u24 v135, 384, v134
    v_add_u32 v135, v135, v132
    v_bfe_u32 v134, v134, 1, 3
    v_xor_b32 v104, s62, v134
    v_lshl_add_u32 v104, v104, 4, v135
    v_add_u32 v136, s64, v130
    v_xor_b32 v103, v136, v134
    v_lshl_add_u32 v103, v103, 4, v135
    s_mul_i32 s62, s3, 1536
    s_add_u32 s62, s62, 49152
    v_lshlrev_b32 v110, 3, v0
    v_add_u32 v109, s62, v110
    v_add_u32 v111, 49152, v114
    s_lshr_b32 s62, s3, 2
    s_lshl_b32 s62, s62, 10
    s_and_b32 s63, s3, 3
    s_lshl_b32 s63, s63, 2
    s_add_u32 s62, s62, s63
    v_add_u32 v112, s62, v111
    s_lshl_b32 s62, s3, 11
    v_add_u32 v111, s62, v111
    s_and_b32 s34, s3, 3
    s_lshr_b32 s35, s34, 1
    s_and_b32 s36, s34, 1
    s_mul_i32 s62, s35, 13824
    s_add_u32 s62, s62, 49152
    v_add_u32 v117, s62, v110
    v_add_u32 v110, 55296, v109
    v_and_b32 v132, 1, v126
    v_lshlrev_b32 v132, 4, v132
    v_mov_b32 v133, 0xffff
    v_lshlrev_b32 v133, v132, v133
    v_bfe_i32 v132, v126, 1, 1
    v_bfe_i32 v134, v126, 2, 1
    v_and_b32 v122, v133, v134
    v_xor_b32 v120, v133, v122
    v_and_b32 v123, v122, v132
    v_xor_b32 v122, v122, v123
    v_and_b32 v121, v120, v132
    v_xor_b32 v120, v120, v121
    v_not_b32 v132, v127
    v_ashrrev_i32 v132, 31, v132
    v_add_u32 v133, -1, v127
    v_ashrrev_i32 v133, 31, v133
    v_bfe_i32 v134, v0, 5, 1
    v_and_b32 v44, v120, v132
    v_and_b32 v52, v44, v134
    v_xor_b32 v48, v52, v44
    v_and_b32 v45, v121, v132
    v_and_b32 v53, v45, v134
    v_xor_b32 v49, v53, v45
    v_and_b32 v46, v122, v132
    v_and_b32 v54, v46, v134
    v_xor_b32 v50, v54, v46
    v_and_b32 v47, v123, v132
    v_and_b32 v55, v47, v134
    v_xor_b32 v51, v55, v47
    v_and_b32 v56, v120, v133
    v_and_b32 v64, v56, v134
    v_xor_b32 v60, v64, v56
    v_and_b32 v57, v121, v133
    v_and_b32 v65, v57, v134
    v_xor_b32 v61, v65, v57
    v_and_b32 v58, v122, v133
    v_and_b32 v66, v58, v134
    v_xor_b32 v62, v66, v58
    v_and_b32 v59, v123, v133
    v_and_b32 v67, v59, v134
    v_xor_b32 v63, v67, v59
    v_mul_u32_u24 v120, 6912, v125
    v_and_b32 v121, 31, v0
    v_lshlrev_b32 v121, 3, v121
    v_add_u32 v121, 162048, v121
    s_lshl_b32 s62, s3, 8
    v_add_u32 v122, s62, v121
    v_mov_b32 v10, 0
    v_mov_b32 v11, 0
    v_mov_b32 v42, 0
    s_cmp_ge_u32 s3, 4
    s_cbranch_scc1 L_Qs
    v_bfe_u32 v244, v0, 2, 2
    v_lshlrev_b32 v244, 6, v244
    v_bfe_u32 v245, v0, 4, 1
    v_lshrrev_b32 v246, 5, v0
    v_and_b32 v247, 1, v0
    v_bfe_u32 v248, v0, 1, 1
    v_lshl_add_u32 v249, v246, 8, v244
    v_lshl_add_u32 v250, v245, 1, v248
    v_xor_b32 v250, v250, v246
    v_lshl_add_u32 v1, v250, 4, v249
    v_lshl_add_u32 v1, v247, 3, v1
    s_lshl_b32 s62, s36, 9
    v_add_u32 v1, s62, v1
    v_lshlrev_b32 v2, 4, v246
    s_lshl_b32 s62, s36, 7
    s_add_u32 s62, s62, 152832
    v_add_u32 v2, s62, v2
    s_mul_i32 s62, s35, 12288
    s_lshl_b32 s63, s36, 11
    s_add_u32 s62, s62, s63
    s_add_u32 s62, s62, 98304
    v_add_u32 v3, s62, v114
    v_add_u32 v252, 55296, v117
    v_and_b32 v92, 1, v0
    v_lshlrev_b32 v92, 4, v92
    v_mov_b32 v93, 0x3f80
    v_lshlrev_b32 v92, v92, v93
    v_lshrrev_b32 v93, 3, v0
    v_xnor_b32 v93, v93, v0
    v_bfe_i32 v93, v93, 2, 1
    v_and_b32 v26, v92, v93
    v_bfe_i32 v92, v0, 4, 1
    v_bfe_i32 v93, v0, 3, 1
    v_bfe_i32 v94, v0, 1, 1
    v_and_b32 v30, v26, v92
    v_xor_b32 v26, v26, v30
    v_and_b32 v28, v26, v93
    v_xor_b32 v26, v26, v28
    v_and_b32 v32, v30, v93
    v_xor_b32 v30, v30, v32
    v_and_b32 v27, v26, v94
    v_xor_b32 v26, v26, v27
    v_and_b32 v29, v28, v94
    v_xor_b32 v28, v28, v29
    v_and_b32 v31, v30, v94
    v_xor_b32 v30, v30, v31
    v_and_b32 v33, v32, v94
    v_xor_b32 v32, v32, v33
    v_add_u32 v34, 0, v0
    v_mul_u32_u24 v40, 2731, v34
    v_bfe_u32 v41, v40, 16, 1
    v_bfe_u32 v40, v40, 17, 3
    v_lshlrev_b32 v41, 2, v41
    v_xor_b32 v40, v40, v41
    v_xor_b32 v34, v34, v40
    v_lshlrev_b32 v34, 4, v34
    v_add_u32 v35, 64, v0
    v_mul_u32_u24 v40, 2731, v35
    v_bfe_u32 v41, v40, 16, 1
    v_bfe_u32 v40, v40, 17, 3
    v_lshlrev_b32 v41, 2, v41
    v_xor_b32 v40, v40, v41
    v_xor_b32 v35, v35, v40
    v_lshlrev_b32 v35, 4, v35
    v_add_u32 v36, 128, v0
    v_mul_u32_u24 v40, 2731, v36
    v_bfe_u32 v41, v40, 16, 1
    v_bfe_u32 v40, v40, 17, 3
    v_lshlrev_b32 v41, 2, v41
    v_xor_b32 v40, v40, v41
    v_xor_b32 v36, v36, v40
    v_lshlrev_b32 v36, 4, v36
    v_add_u32 v37, 192, v0
    v_mul_u32_u24 v40, 2731, v37
    v_bfe_u32 v41, v40, 16, 1
    v_bfe_u32 v40, v40, 17, 3
    v_lshlrev_b32 v41, 2, v41
    v_xor_b32 v40, v40, v41
    v_xor_b32 v37, v37, v40
    v_lshlrev_b32 v37, 4, v37
    v_add_u32 v38, 256, v0
    v_mul_u32_u24 v40, 2731, v38
    v_bfe_u32 v41, v40, 16, 1
    v_bfe_u32 v40, v40, 17, 3
    v_lshlrev_b32 v41, 2, v41
    v_xor_b32 v40, v40, v41
    v_xor_b32 v38, v38, v40
    v_lshlrev_b32 v38, 4, v38
    v_add_u32 v39, 320, v0
    v_mul_u32_u24 v40, 2731, v39
    v_bfe_u32 v41, v40, 16, 1
    v_bfe_u32 v40, v40, 17, 3
    v_lshlrev_b32 v41, 2, v41
    v_xor_b32 v40, v40, v41
    v_xor_b32 v39, v39, v40
    v_lshlrev_b32 v39, 4, v39
    v_add_u32 v92, 157952, v114
    ds_write_b128 v92, v[26:29] offset:0
    ds_write_b128 v92, v[30:33] offset:1024
    ds_write_b128 v92, v[34:37] offset:2048
    ds_write_b128 v92, v[38:41] offset:3072
    s_branch L_sdone
L_Qs:
    v_bfe_u32 v244, v0, 2, 2
    v_lshlrev_b32 v244, 6, v244
    v_bfe_u32 v245, v0, 4, 1
    v_lshrrev_b32 v246, 5, v0
    v_and_b32 v247, 1, v0
    v_bfe_u32 v248, v0, 1, 1
    v_mov_b32 v10, v115
    v_mov_b32 v11, v116
    v_mov_b32 v6, v114
    v_add_u32 v10, 256, v10
    v_lshl_add_u32 v249, v246, 8, v244
    v_xor_b32 v250, v245, v246
    v_lshl_add_u32 v250, v250, 1, v247
    v_lshl_add_u32 v1, v250, 4, v249
    v_lshl_add_u32 v1, v248, 3, v1
    s_mul_i32 s62, s36, 1536
    s_add_u32 s62, s62, 49152
    v_add_u32 v1, s62, v1
    s_mul_i32 s62, s35, 12288
    s_add_u32 s62, s62, 98304
    v_add_u32 v2, s62, v6
    v_lshl_add_u32 v249, v245, 8, v244
    v_lshl_add_u32 v249, v247, 3, v249
    v_lshlrev_b32 v250, 1, v248
    v_add_u32 v250, s36, v250
    v_xor_b32 v250, v250, v245
    v_lshl_add_u32 v3, v250, 4, v249
    v_lshl_add_u32 v3, v246, 11, v3
    s_lshl_b32 s62, s35, 9
    v_add_u32 v3, s62, v3
    v_lshlrev_b32 v4, 6, v246
    v_lshl_add_u32 v4, v245, 4, v4
    s_lshl_b32 s62, s35, 7
    s_lshl_b32 s65, s36, 5
    s_add_u32 s62, s62, s65
    s_add_u32 s62, s62, 152832
    v_add_u32 v4, s62, v4
    s_lshl_b32 s62, s35, 10
    s_lshl_b32 s65, s36, 3
    s_add_u32 s62, s62, s65
    s_add_u32 s62, s62, 147456
    v_add_u32 v5, s62, v6
    v_mul_u32_u24 v251, 6144, v246
    v_add_u32 v249, v249, v251
    s_mul_i32 s64, s34, 3
    s_add_u32 s62, s64, 0
    s_and_b32 s65, s62, 1
    v_xor_b32 v250, s65, v245
    v_lshl_add_u32 v250, v250, 1, v248
    v_lshl_add_u32 v7, v250, 4, v249
    s_lshr_b32 s62, s62, 1
    s_lshl_b32 s62, s62, 9
    s_add_u32 s62, s62, 49152
    v_add_u32 v7, s62, v7
    s_add_u32 s62, s64, 1
    s_and_b32 s65, s62, 1
    v_xor_b32 v250, s65, v245
    v_lshl_add_u32 v250, v250, 1, v248
    v_lshl_add_u32 v8, v250, 4, v249
    s_lshr_b32 s62, s62, 1
    s_lshl_b32 s62, s62, 9
    s_add_u32 s62, s62, 49152
    v_add_u32 v8, s62, v8
    s_mul_i32 s40, s34, 73728
    s_mul_i32 s46, s34, 6144
    s_mul_i32 s52, s34, 6144
    s_add_u32 s41, s40, 12288
    s_add_u32 s47, s46, 128
    s_add_u32 s42, s40, 24576
    s_add_u32 s48, s46, 256
    s_add_u32 s43, s40, 36864
    s_add_u32 s49, s46, 3072
    s_add_u32 s44, s40, 49152
    s_add_u32 s50, s46, 3200
    s_add_u32 s45, s40, 61440
    s_add_u32 s51, s46, 3328
    v_and_b32 v252, 15, v0
    v_lshlrev_b32 v252, 3, v252
    v_lshl_add_u32 v252, v245, 8, v252
    v_lshl_add_u32 v252, v246, 10, v252
    v_add_u32 v252, 132096, v252
    v_lshlrev_b32 v253, 5, v246
    s_mul_i32 s62, s36, 384
    s_add_u32 s62, s62, 155904
    v_add_u32 v253, s62, v253
    v_lshrrev_b32 v254, 4, v0
    v_lshlrev_b32 v254, 4, v254
    s_mul_i32 s62, s34, 192
    s_add_u32 s62, s62, 155904
    v_add_u32 v254, s62, v254
    v_add_u32 v6, 147456, v6
    v_and_b32 v92, 31, v0
    v_mul_u32_u24 v93, 384, v92
    s_mul_i32 s62, s35, 12288
    v_add_u32 v93, s62, v93
    v_bfe_u32 v92, v92, 1, 3
    v_and_b32 v9, 1, v0
    v_lshlrev_b32 v9, 2, v9
    v_xor_b32 v92, v92, v9
    v_lshrrev_b32 v9, 5, v0
    v_xor_b32 v92, v92, v9
    s_lshl_b32 s62, s36, 2
    v_xor_b32 v92, s62, v92
    s_lshl_b32 s62, s36, 7
    v_add_u32 v93, s62, v93
    v_xor_b32 v12, 0, v92
    v_lshl_add_u32 v12, v12, 4, v93
    v_xor_b32 v13, 2, v92
    v_lshl_add_u32 v13, v13, 4, v93
    v_add_u32 v93, s62, v93
    v_xor_b32 v14, 4, v92
    v_lshl_add_u32 v14, v14, 4, v93
    v_xor_b32 v15, 6, v92
    v_lshl_add_u32 v15, v15, 4, v93
    v_lshlrev_b32 v9, 5, v9
    s_mul_i32 s62, s36, 384
    s_add_u32 s62, s62, 156928
    v_add_u32 v9, s62, v9
    v_and_b32 v42, 15, v0
    v_mul_u32_u24 v42, 384, v42
    v_lshrrev_b32 v43, 4, v0
    v_lshl_add_u32 v42, v43, 3, v42
    v_lshlrev_b32 v43, 4, v43
    s_mul_i32 s62, s34, 192
    s_add_u32 s62, s62, 156928
    v_add_u32 v43, s62, v43
    s_add_u32 s53, s4, 12
    s_mul_i32 s53, s53, 86016
    s_mul_i32 s63, s5, 384
    s_add_u32 s53, s53, s63
    s_mul_i32 s63, s34, 96
    s_add_u32 s53, s53, s63
    s_cmp_eq_u32 s6, 12
    s_cselect_b32 s53, 1073741824, s53
    s_add_u32 s54, s4, s34
    s_mul_i32 s54, s54, 86016
    s_mul_i32 s63, s5, 384
    s_add_u32 s54, s54, s63
    s_add_u32 s55, s54, 344064
L_sdone:
    s_mul_i32 s64, s3, 3072
    s_mul_i32 s65, s3, 36864
    s_mov_b64 vcc, s[38:39]
    s_cbranch_vccz L_nox4
    s_mov_b64 exec, vcc
    s_add_u32 m0, s33, 27648
    s_nop 0
    buffer_load_dwordx4 v113, s[8:11], s32 offen lds
    s_add_u32 s32, s32, 86016
    s_mov_b64 exec, -1
L_nox4:
    s_cbranch_vccz L_nox5
    s_mov_b64 exec, vcc
    s_add_u32 m0, s33, 34560
    s_nop 0
    buffer_load_dwordx4 v113, s[8:11], s32 offen lds
    s_add_u32 s32, s32, 86016
    s_mov_b64 exec, -1
L_nox5:
    s_cbranch_vccz L_nox6
    s_mov_b64 exec, vcc
    s_add_u32 m0, s33, 41472
    s_nop 0
    buffer_load_dwordx4 v113, s[8:11], s32 offen lds
    s_add_u32 s32, s32, 86016
    s_mov_b64 exec, -1
L_nox6:
    s_waitcnt vmcnt(5)
    s_barrier
    ds_read_b128 v[148:151], v105 offset:0
    ds_read_b128 v[152:155], v105 offset:16
    ds_read_b128 v[156:159], v105 offset:32
    ds_read_b128 v[160:163], v107 offset:768
    ds_read_b128 v[164:167], v107 offset:784
    ds_read_b128 v[168:171], v107 offset:800
    ds_read_b128 v[172:175], v106 offset:0
    ds_read_b128 v[176:179], v106 offset:16
    ds_read_b128 v[180:183], v106 offset:32
    ds_read_b128 v[184:187], v108 offset:768
    ds_read_b128 v[188:191], v108 offset:784
    ds_read_b128 v[192:195], v108 offset:800
    ds_read_b128 v[196:199], v100 offset:0
    ds_read_b128 v[200:203], v101 offset:0
    ds_read_b128 v[204:207], v102 offset:0
    ds_read_b128 v[208:211], v103 offset:0
    ds_read_b128 v[212:215], v104 offset:0
    s_cbranch_vccz L_nox7
    s_mov_b64 exec, vcc
    s_add_u32 m0, s33, 48384
    s_nop 0
    buffer_load_dwordx4 v113, s[8:11], s32 offen lds
    s_add_u32 s32, s32, 86016
    s_mov_b64 exec, -1
L_nox7:
    s_cbranch_vccz L_nox8
    s_mov_b64 exec, vcc
    s_add_u32 m0, s33, 55296
    s_nop 0
    buffer_load_dwordx4 v113, s[8:11], s32 offen lds
    s_add_u32 s32, s32, 86016
    s_mov_b64 exec, -1
L_nox8:
    s_waitcnt lgkmcnt(14)
    v_and_b32 v148, v148, v44
    v_and_b32 v149, v149, v45
    v_and_b32 v150, v150, v46
    v_and_b32 v151, v151, v47
    v_and_b32 v152, v152, v44
    v_and_b32 v153, v153, v45
    v_and_b32 v154, v154, v46
    v_and_b32 v155, v155, v47
    v_and_b32 v156, v156, v44
    v_and_b32 v157, v157, v45
    v_and_b32 v158, v158, v46
    v_and_b32 v159, v159, v47
    s_waitcnt lgkmcnt(13)
    v_and_b32 v160, v160, v48
    v_and_b32 v161, v161, v49
    v_and_b32 v162, v162, v50
    v_and_b32 v163, v163, v51
    s_waitcnt lgkmcnt(12)
    v_and_b32 v164, v164, v52
    v_and_b32 v165, v165, v53
    v_and_b32 v166, v166, v54
    v_and_b32 v167, v167, v55
    s_waitcnt lgkmcnt(11)
    v_and_b32 v168, v168, v48
    v_and_b32 v169, v169, v49
    v_and_b32 v170, v170, v50
    v_and_b32 v171, v171, v51
    s_waitcnt lgkmcnt(10)
    v_and_b32 v172, v172, v56
    v_and_b32 v173, v173, v57
    v_and_b32 v174, v174, v58
    v_and_b32 v175, v175, v59
    s_waitcnt lgkmcnt(9)
    v_and_b32 v176, v176, v56
    v_and_b32 v177, v177, v57
    v_and_b32 v178, v178, v58
    v_and_b32 v179, v179, v59
    s_waitcnt lgkmcnt(8)
    v_and_b32 v180, v180, v56
    v_and_b32 v181, v181, v57
    v_and_b32 v182, v182, v58
    v_and_b32 v183, v183, v59
    s_waitcnt lgkmcnt(7)
    v_and_b32 v184, v184, v60
    v_and_b32 v185, v185, v61
    v_and_b32 v186, v186, v62
    v_and_b32 v187, v187, v63
    s_waitcnt lgkmcnt(6)
    v_and_b32 v188, v188, v64
    v_and_b32 v189, v189, v65
    v_and_b32 v190, v190, v66
    v_and_b32 v191, v191, v67
    s_waitcnt lgkmcnt(5)
    v_and_b32 v192, v192, v60
    v_and_b32 v193, v193, v61
    v_and_b32 v194, v194, v62
    v_and_b32 v195, v195, v63
    s_waitcnt vmcnt(5)
    s_barrier
    s_waitcnt lgkmcnt(4)
    v_mfma_f32_16x16x32_bf16 v[44:47], v[148:151], v[196:199], 0
    ds_read_b128 v[216:219], v100 offset:13824
    s_waitcnt lgkmcnt(4)
    v_mfma_f32_16x16x32_bf16 v[48:51], v[152:155], v[200:203], 0
    ds_read_b128 v[220:223], v101 offset:13824
    s_cbranch_vccz L_nox9
    s_mov_b64 exec, vcc
    s_add_u32 m0, s33, 62208
    s_nop 0
    buffer_load_dwordx4 v113, s[8:11], s32 offen lds
    s_add_u32 s32, s32, 86016
    s_mov_b64 exec, -1
L_nox9:
    s_waitcnt lgkmcnt(4)
    v_mfma_f32_16x16x32_bf16 v[52:55], v[156:159], v[204:207], 0
    ds_read_b128 v[224:227], v102 offset:13824
    s_waitcnt lgkmcnt(4)
    v_mfma_f32_16x16x32_bf16 v[44:47], v[160:163], v[208:211], v[44:47]
    ds_read_b128 v[228:231], v103 offset:13824
    s_cbranch_vccz L_nox10
    s_mov_b64 exec, vcc
    s_add_u32 m0, s33, 69120
    s_nop 0
    buffer_load_dwordx4 v113, s[8:11], s32 offen lds
    s_add_u32 s32, s32, 86016
    s_mov_b64 exec, -1
L_nox10:
    v_mfma_f32_16x16x32_bf16 v[48:51], v[164:167], v[208:211], v[48:51]
    ds_read_b128 v[232:235], v104 offset:13824
    s_cbranch_vccz L_nox11
    s_mov_b64 exec, vcc
    s_add_u32 m0, s33, 76032
    s_nop 0
    buffer_load_dwordx4 v113, s[8:11], s32 offen lds
    s_add_u32 s32, s32, 86016
    s_mov_b64 exec, -1
L_nox11:
    s_waitcnt lgkmcnt(5)
    v_mfma_f32_16x16x32_bf16 v[52:55], v[168:171], v[212:215], v[52:55]
    s_cmp_eq_u32 s3, 7
    s_cbranch_scc0 L_notab2
    s_waitcnt vmcnt(0)
    v_add_u32 v144, 152832, v114
    v_lshlrev_b32 v124, 16, v16
    v_and_b32 v125, 0xffff0000, v16
    v_lshlrev_b32 v126, 16, v17
    v_and_b32 v127, 0xffff0000, v17
    v_mul_f32 v124, 0x3eeff558, v124
    v_mul_f32 v125, 0x3eeff558, v125
    v_mul_f32 v126, 0x3eeff558, v126
    v_mul_f32 v127, 0x3eeff558, v127
    v_lshlrev_b32 v128, 16, v18
    v_and_b32 v129, 0xffff0000, v18
    v_lshlrev_b32 v130, 16, v19
    v_and_b32 v131, 0xffff0000, v19
    v_mul_f32 v128, 0x3eeff558, v128
    v_mul_f32 v129, 0x3eeff558, v129
    v_mul_f32 v130, 0x3eeff558, v130
    v_mul_f32 v131, 0x3eeff558, v131
    v_lshlrev_b32 v132, 16, v20
    v_and_b32 v133, 0xffff0000, v20
    v_lshlrev_b32 v134, 16, v21
    v_and_b32 v135, 0xffff0000, v21
    v_mul_f32 v132, 0x3eeff558, v132
    v_mul_f32 v133, 0x3eeff558, v133
    v_mul_f32 v134, 0x3eeff558, v134
    v_mul_f32 v135, 0x3eeff558, v135
    v_lshlrev_b32 v136, 16, v22
    v_and_b32 v137, 0xffff0000, v22
    v_lshlrev_b32 v138, 16, v23
    v_and_b32 v139, 0xffff0000, v23
    v_mul_f32 v136, 0x3eeff558, v136
    v_mul_f32 v137, 0x3eeff558, v137
    v_mul_f32 v138, 0x3eeff558, v138
    v_mul_f32 v139, 0x3eeff558, v139
    v_lshlrev_b32 v140, 16, v24
    v_and_b32 v141, 0xffff0000, v24
    v_lshlrev_b32 v142, 16, v25
    v_and_b32 v143, 0xffff0000, v25
    v_mul_f32 v140, 0x40088e99, v140
    v_mul_f32 v141, 0x40088e99, v141
    v_mul_f32 v142, 0x40088e99, v142
    v_mul_f32 v143, 0x40088e99, v143
    ds_write_b128 v144, v[124:127] offset:0
    ds_write_b128 v144, v[128:131] offset:1024
    ds_write_b128 v144, v[132:135] offset:2048
    ds_write_b128 v144, v[136:139] offset:3072
    ds_write_b128 v144, v[140:143] offset:4096
L_notab2:
    s_waitcnt lgkmcnt(4)
    v_mfma_f32_16x16x32_bf16 v[44:47], v[172:175], v[216:219], v[44:47]
    s_waitcnt lgkmcnt(3)
    v_mfma_f32_16x16x32_bf16 v[48:51], v[176:179], v[220:223], v[48:51]
    s_waitcnt lgkmcnt(2)
    v_mfma_f32_16x16x32_bf16 v[52:55], v[180:183], v[224:227], v[52:55]
    s_waitcnt lgkmcnt(1)
    v_mfma_f32_16x16x32_bf16 v[44:47], v[184:187], v[228:231], v[44:47]
    v_mfma_f32_16x16x32_bf16 v[48:51], v[188:191], v[228:231], v[48:51]
    s_waitcnt lgkmcnt(0)
    v_mfma_f32_16x16x32_bf16 v[52:55], v[192:195], v[232:235], v[52:55]
    s_waitcnt vmcnt(6)
    s_barrier
    v_mfma_f32_16x16x32_bf16 v[56:59], v[148:151], v[216:219], 0
    ds_read_b128 v[196:199], v100 offset:27648
    v_mfma_f32_16x16x32_bf16 v[60:63], v[152:155], v[220:223], 0
    ds_read_b128 v[200:203], v101 offset:27648
    s_cbranch_vccz L_nox12
    s_mov_b64 exec, vcc
    s_add_u32 m0, s33, 82944
    s_nop 0
    buffer_load_dwordx4 v113, s[8:11], s32 offen lds
    s_add_u32 s32, s32, 86016
    s_mov_b64 exec, -1
L_nox12:
    v_add_f32 v248, v44, v45
    v_mul_f32 v249, v44, v44
    v_mfma_f32_16x16x32_bf16 v[64:67], v[156:159], v[224:227], 0
    ds_read_b128 v[204:207], v102 offset:27648
    v_add_f32 v250, v46, v47
    v_mul_f32 v251, v45, v45
    v_mfma_f32_16x16x32_bf16 v[56:59], v[160:163], v[228:231], v[56:59]
    ds_read_b128 v[208:211], v103 offset:27648
    s_cbranch_vccz L_nox13
    s_mov_b64 exec, vcc
    s_add_u32 m0, s33, 89856
    s_nop 0
    buffer_load_dwordx4 v113, s[8:11], s32 offen lds
    s_add_u32 s32, s32, 86016
    s_mov_b64 exec, -1
L_nox13:
    v_fmac_f32 v249, v46, v46
    v_fmac_f32 v251, v47, v47
    v_mfma_f32_16x16x32_bf16 v[60:63], v[164:167], v[228:231], v[60:63]
    ds_read_b128 v[212:215], v104 offset:27648
    s_cbranch_vccz L_nox14
    s_mov_b64 exec, vcc
    s_add_u32 m0, s33, 96768
    s_cmp_eq_u32 s6, 12
    s_cselect_b32 s62, 1073741824, s32
    buffer_load_dwordx4 v113, s[8:11], s62 offen lds
    s_add_u32 s32, s32, 86016
    s_mov_b64 exec, -1
L_nox14:
    v_add_f32 v248, v248, v48
    v_fmac_f32 v249, v48, v48
    v_mfma_f32_16x16x32_bf16 v[64:67], v[168:171], v[232:235], v[64:67]
    v_add_f32 v250, v250, v49
    v_fmac_f32 v251, v49, v49
    s_waitcnt lgkmcnt(4)
    v_mfma_f32_16x16x32_bf16 v[56:59], v[172:175], v[196:199], v[56:59]
    s_waitcnt lgkmcnt(3)
    v_add_f32 v248, v248, v50
    v_fmac_f32 v249, v50, v50
    v_add_f32 v250, v250, v51
    v_mfma_f32_16x16x32_bf16 v[60:63], v[176:179], v[200:203], v[60:63]
    s_waitcnt lgkmcnt(2)
    v_fmac_f32 v251, v51, v51
    v_add_f32 v248, v248, v52
    v_fmac_f32 v249, v52, v52
    v_mfma_f32_16x16x32_bf16 v[64:67], v[180:183], v[204:207], v[64:67]
    s_waitcnt lgkmcnt(1)
    v_add_f32 v250, v250, v53
    v_fmac_f32 v251, v53, v53
    v_add_f32 v248, v248, v54
    v_mfma_f32_16x16x32_bf16 v[56:59], v[184:187], v[208:211], v[56:59]
    v_fmac_f32 v249, v54, v54
    v_add_f32 v250, v250, v55
    v_fmac_f32 v251, v55, v55
    v_mfma_f32_16x16x32_bf16 v[60:63], v[188:191], v[208:211], v[60:63]
    s_waitcnt lgkmcnt(0)
    v_add_f32 v248, v248, v250
    v_add_f32 v249, v249, v251
    s_nop 1
    v_permlane32_swap_b32 v248, v249
    v_mfma_f32_16x16x32_bf16 v[64:67], v[192:195], v[212:215], v[64:67]
    s_waitcnt vmcnt(7)
    s_barrier
    v_add_f32 v92, v248, v249
    ds_write_b32 v112, v92 offset:0
    v_mfma_f32_16x16x32_bf16 v[68:71], v[148:151], v[196:199], 0
    ds_read_b128 v[216:219], v100 offset:41472
    v_mfma_f32_16x16x32_bf16 v[72:75], v[152:155], v[200:203], 0
    ds_read_b128 v[220:223], v101 offset:41472
    v_add_f32 v248, v56, v57
    v_mul_f32 v249, v56, v56
    v_mfma_f32_16x16x32_bf16 v[76:79], v[156:159], v[204:207], 0
    ds_read_b128 v[224:227], v102 offset:41472
    v_add_f32 v250, v58, v59
    v_mul_f32 v251, v57, v57
    v_mfma_f32_16x16x32_bf16 v[68:71], v[160:163], v[208:211], v[68:71]
    ds_read_b128 v[228:231], v103 offset:41472
    v_fmac_f32 v249, v58, v58
    v_fmac_f32 v251, v59, v59
    v_mfma_f32_16x16x32_bf16 v[72:75], v[164:167], v[208:211], v[72:75]
    ds_read_b128 v[232:235], v104 offset:41472
    v_add_f32 v248, v248, v60
    v_fmac_f32 v249, v60, v60
    v_mfma_f32_16x16x32_bf16 v[76:79], v[168:171], v[212:215], v[76:79]
    v_add_f32 v250, v250, v61
    v_fmac_f32 v251, v61, v61
    s_waitcnt lgkmcnt(4)
    v_mfma_f32_16x16x32_bf16 v[68:71], v[172:175], v[216:219], v[68:71]
    s_waitcnt lgkmcnt(3)
    v_add_f32 v248, v248, v62
    v_fmac_f32 v249, v62, v62
    v_add_f32 v250, v250, v63
    v_mfma_f32_16x16x32_bf16 v[72:75], v[176:179], v[220:223], v[72:75]
    s_waitcnt lgkmcnt(2)
    v_fmac_f32 v251, v63, v63
    v_add_f32 v248, v248, v64
    v_fmac_f32 v249, v64, v64
    v_mfma_f32_16x16x32_bf16 v[76:79], v[180:183], v[224:227], v[76:79]
    s_waitcnt lgkmcnt(1)
    v_add_f32 v250, v250, v65
    v_fmac_f32 v251, v65, v65
    v_add_f32 v248, v248, v66
    v_mfma_f32_16x16x32_bf16 v[68:71], v[184:187], v[228:231], v[68:71]
    v_fmac_f32 v249, v66, v66
    v_add_f32 v250, v250, v67
    v_fmac_f32 v251, v67, v67
    v_mfma_f32_16x16x32_bf16 v[72:75], v[188:191], v[228:231], v[72:75]
    s_waitcnt lgkmcnt(0)
    v_add_f32 v248, v248, v250
    v_add_f32 v249, v249, v251
    s_nop 1
    v_permlane32_swap_b32 v248, v249
    v_mfma_f32_16x16x32_bf16 v[76:79], v[192:195], v[232:235], v[76:79]
    s_waitcnt vmcnt(5)
    s_barrier
    v_add_f32 v93, v248, v249
    ds_write_b32 v112, v93 offset:2048
    v_mfma_f32_16x16x32_bf16 v[80:83], v[148:151], v[216:219], 0
    ds_read_b128 v[196:199], v100 offset:55296
    v_mfma_f32_16x16x32_bf16 v[84:87], v[152:155], v[220:223], 0
    ds_read_b128 v[200:203], v101 offset:55296
    s_add_u32 m0, s64, 0
    s_add_u32 s62, s65, 0
    buffer_load_dwordx4 v115, s[16:19], s62 offen lds
    v_add_f32 v248, v68, v69
    v_mul_f32 v249, v68, v68
    v_mfma_f32_16x16x32_bf16 v[88:91], v[156:159], v[224:227], 0
    ds_read_b128 v[204:207], v102 offset:55296
    v_add_f32 v250, v70, v71
    v_mul_f32 v251, v69, v69
    v_mfma_f32_16x16x32_bf16 v[80:83], v[160:163], v[228:231], v[80:83]
    ds_read_b128 v[208:211], v103 offset:55296
    s_add_u32 m0, s64, 1024
    s_add_u32 s62, s65, 12288
    buffer_load_dwordx4 v115, s[16:19], s62 offen lds
    v_fmac_f32 v249, v70, v70
    v_fmac_f32 v251, v71, v71
    v_mfma_f32_16x16x32_bf16 v[84:87], v[164:167], v[228:231], v[84:87]
    ds_read_b128 v[212:215], v104 offset:55296
    s_add_u32 m0, s64, 2048
    s_add_u32 s62, s65, 24576
    buffer_load_dwordx4 v115, s[16:19], s62 offen lds
    v_add_f32 v248, v248, v72
    v_fmac_f32 v249, v72, v72
    v_mfma_f32_16x16x32_bf16 v[88:91], v[168:171], v[232:235], v[88:91]
    v_add_f32 v250, v250, v73
    v_fmac_f32 v251, v73, v73
    s_waitcnt lgkmcnt(4)
    v_mfma_f32_16x16x32_bf16 v[80:83], v[172:175], v[196:199], v[80:83]
    s_waitcnt lgkmcnt(3)
    v_add_f32 v248, v248, v74
    v_fmac_f32 v249, v74, v74
    v_add_f32 v250, v250, v75
    v_mfma_f32_16x16x32_bf16 v[84:87], v[176:179], v[200:203], v[84:87]
    s_waitcnt lgkmcnt(2)
    v_fmac_f32 v251, v75, v75
    v_add_f32 v248, v248, v76
    v_fmac_f32 v249, v76, v76
    v_mfma_f32_16x16x32_bf16 v[88:91], v[180:183], v[204:207], v[88:91]
    s_waitcnt lgkmcnt(1)
    v_add_f32 v250, v250, v77
    v_fmac_f32 v251, v77, v77
    v_add_f32 v248, v248, v78
    v_mfma_f32_16x16x32_bf16 v[80:83], v[184:187], v[208:211], v[80:83]
    v_fmac_f32 v249, v78, v78
    v_add_f32 v250, v250, v79
    v_fmac_f32 v251, v79, v79
    v_mfma_f32_16x16x32_bf16 v[84:87], v[188:191], v[208:211], v[84:87]
    s_waitcnt lgkmcnt(0)
    v_add_f32 v248, v248, v250
    v_add_f32 v249, v249, v251
    s_nop 1
    v_permlane32_swap_b32 v248, v249
    v_mfma_f32_16x16x32_bf16 v[88:91], v[192:195], v[212:215], v[88:91]
    s_waitcnt vmcnt(6)
    s_barrier
    v_add_u32 v100, 55296, v100
    v_add_u32 v101, 55296, v101
    v_add_u32 v102, 55296, v102
    v_add_u32 v103, 55296, v103
    v_add_u32 v104, 55296, v104
    v_add_f32 v92, v248, v249
    ds_write_b32 v112, v92 offset:4096
    v_mfma_f32_16x16x32_bf16 v[124:127], v[148:151], v[196:199], 0
    ds_read_b128 v[216:219], v100 offset:13824
    v_mfma_f32_16x16x32_bf16 v[128:131], v[152:155], v[200:203], 0
    ds_read_b128 v[220:223], v101 offset:13824
    s_add_u32 m0, s64, 24576
    s_add_u32 s62, s65, 128
    buffer_load_dwordx4 v115, s[16:19], s62 offen lds
    v_add_f32 v248, v80, v81
    v_mul_f32 v249, v80, v80
    v_mfma_f32_16x16x32_bf16 v[132:135], v[156:159], v[204:207], 0
    ds_read_b128 v[224:227], v102 offset:13824
    v_add_f32 v250, v82, v83
    v_mul_f32 v251, v81, v81
    v_mfma_f32_16x16x32_bf16 v[124:127], v[160:163], v[208:211], v[124:127]
    ds_read_b128 v[228:231], v103 offset:13824
    s_add_u32 m0, s64, 25600
    s_add_u32 s62, s65, 12416
    buffer_load_dwordx4 v115, s[16:19], s62 offen lds
    v_fmac_f32 v249, v82, v82
    v_fmac_f32 v251, v83, v83
    v_mfma_f32_16x16x32_bf16 v[128:131], v[164:167], v[208:211], v[128:131]
    ds_read_b128 v[232:235], v104 offset:13824
    s_add_u32 m0, s64, 26624
    s_add_u32 s62, s65, 24704
    buffer_load_dwordx4 v115, s[16:19], s62 offen lds
    v_add_f32 v248, v248, v84
    v_fmac_f32 v249, v84, v84
    v_mfma_f32_16x16x32_bf16 v[132:135], v[168:171], v[212:215], v[132:135]
    v_add_f32 v250, v250, v85
    v_fmac_f32 v251, v85, v85
    s_waitcnt lgkmcnt(4)
    v_mfma_f32_16x16x32_bf16 v[124:127], v[172:175], v[216:219], v[124:127]
    s_waitcnt lgkmcnt(3)
    v_add_f32 v248, v248, v86
    v_fmac_f32 v249, v86, v86
    v_add_f32 v250, v250, v87
    v_mfma_f32_16x16x32_bf16 v[128:131], v[176:179], v[220:223], v[128:131]
    s_waitcnt lgkmcnt(2)
    v_fmac_f32 v251, v87, v87
    v_add_f32 v248, v248, v88
    v_fmac_f32 v249, v88, v88
    v_mfma_f32_16x16x32_bf16 v[132:135], v[180:183], v[224:227], v[132:135]
    s_waitcnt lgkmcnt(1)
    v_add_f32 v250, v250, v89
    v_fmac_f32 v251, v89, v89
    v_add_f32 v248, v248, v90
    v_mfma_f32_16x16x32_bf16 v[124:127], v[184:187], v[228:231], v[124:127]
    v_fmac_f32 v249, v90, v90
    v_add_f32 v250, v250, v91
    v_fmac_f32 v251, v91, v91
    v_mfma_f32_16x16x32_bf16 v[128:131], v[188:191], v[228:231], v[128:131]
    s_waitcnt lgkmcnt(0)
    v_add_f32 v248, v248, v250
    v_add_f32 v249, v249, v251
    s_nop 1
    v_permlane32_swap_b32 v248, v249
    v_mfma_f32_16x16x32_bf16 v[132:135], v[192:195], v[232:235], v[132:135]
    s_waitcnt vmcnt(6)
    s_barrier
    v_add_f32 v93, v248, v249
    ds_write_b32 v112, v93 offset:6144
    v_mfma_f32_16x16x32_bf16 v[136:139], v[148:151], v[216:219], 0
    ds_read_b128 v[196:199], v100 offset:27648
    v_mfma_f32_16x16x32_bf16 v[140:143], v[152:155], v[220:223], 0
    ds_read_b128 v[200:203], v101 offset:27648
    v_add_f32 v248, v124, v125
    v_mul_f32 v249, v124, v124
    v_mfma_f32_16x16x32_bf16 v[144:147], v[156:159], v[224:227], 0
    ds_read_b128 v[204:207], v102 offset:27648
    v_add_f32 v250, v126, v127
    v_mul_f32 v251, v125, v125
    v_mfma_f32_16x16x32_bf16 v[136:139], v[160:163], v[228:231], v[136:139]
    ds_read_b128 v[208:211], v103 offset:27648
    v_fmac_f32 v249, v126, v126
    v_fmac_f32 v251, v127, v127
    v_mfma_f32_16x16x32_bf16 v[140:143], v[164:167], v[228:231], v[140:143]
    ds_read_b128 v[212:215], v104 offset:27648
    v_add_f32 v248, v248, v128
    v_fmac_f32 v249, v128, v128
    v_mfma_f32_16x16x32_bf16 v[144:147], v[168:171], v[232:235], v[144:147]
    v_add_f32 v250, v250, v129
    v_fmac_f32 v251, v129, v129
    s_waitcnt lgkmcnt(4)
    v_mfma_f32_16x16x32_bf16 v[136:139], v[172:175], v[196:199], v[136:139]
    s_waitcnt lgkmcnt(3)
    v_add_f32 v248, v248, v130
    v_fmac_f32 v249, v130, v130
    v_add_f32 v250, v250, v131
    v_mfma_f32_16x16x32_bf16 v[140:143], v[176:179], v[200:203], v[140:143]
    s_waitcnt lgkmcnt(2)
    v_fmac_f32 v251, v131, v131
    v_add_f32 v248, v248, v132
    v_fmac_f32 v249, v132, v132
    v_mfma_f32_16x16x32_bf16 v[144:147], v[180:183], v[204:207], v[144:147]
    s_waitcnt lgkmcnt(1)
    v_add_f32 v250, v250, v133
    v_fmac_f32 v251, v133, v133
    v_add_f32 v248, v248, v134
    v_mfma_f32_16x16x32_bf16 v[136:139], v[184:187], v[208:211], v[136:139]
    v_fmac_f32 v249, v134, v134
    v_add_f32 v250, v250, v135
    v_fmac_f32 v251, v135, v135
    v_mfma_f32_16x16x32_bf16 v[140:143], v[188:191], v[208:211], v[140:143]
    s_waitcnt lgkmcnt(0)
    v_add_f32 v248, v248, v250
    v_add_f32 v249, v249, v251
    s_nop 1
    v_permlane32_swap_b32 v248, v249
    v_mfma_f32_16x16x32_bf16 v[144:147], v[192:195], v[212:215], v[144:147]
    v_sub_u32 v100, v100, v120
    v_sub_u32 v101, v101, v120
    v_sub_u32 v102, v102, v120
    v_sub_u32 v103, v103, v120
    v_sub_u32 v104, v104, v120
    v_add_f32 v92, v248, v249
    ds_write_b32 v112, v92 offset:8192
    v_mfma_f32_16x16x32_bf16 v[236:239], v[148:151], v[196:199], 0
    ds_read_b128 v[216:219], v100 offset:41472
    v_mfma_f32_16x16x32_bf16 v[240:243], v[152:155], v[200:203], 0
    ds_read_b128 v[220:223], v101 offset:41472
    v_add_f32 v248, v136, v137
    v_mul_f32 v249, v136, v136
    v_mfma_f32_16x16x32_bf16 v[244:247], v[156:159], v[204:207], 0
    ds_read_b128 v[224:227], v102 offset:41472
    v_add_f32 v250, v138, v139
    v_mul_f32 v251, v137, v137
    v_mfma_f32_16x16x32_bf16 v[236:239], v[160:163], v[208:211], v[236:239]
    ds_read_b128 v[228:231], v103 offset:41472
    v_fmac_f32 v249, v138, v138
    v_fmac_f32 v251, v139, v139
    v_mfma_f32_16x16x32_bf16 v[240:243], v[164:167], v[208:211], v[240:243]
    ds_read_b128 v[232:235], v104 offset:41472
    v_add_f32 v248, v248, v140
    v_fmac_f32 v249, v140, v140
    v_mfma_f32_16x16x32_bf16 v[244:247], v[168:171], v[212:215], v[244:247]
    v_add_f32 v250, v250, v141
    v_fmac_f32 v251, v141, v141
    s_waitcnt lgkmcnt(4)
    v_mfma_f32_16x16x32_bf16 v[236:239], v[172:175], v[216:219], v[236:239]
    s_waitcnt lgkmcnt(3)
    v_add_f32 v248, v248, v142
    v_fmac_f32 v249, v142, v142
    v_add_f32 v250, v250, v143
    v_mfma_f32_16x16x32_bf16 v[240:243], v[176:179], v[220:223], v[240:243]
    s_waitcnt lgkmcnt(2)
    v_fmac_f32 v251, v143, v143
    v_add_f32 v248, v248, v144
    v_fmac_f32 v249, v144, v144
    v_mfma_f32_16x16x32_bf16 v[244:247], v[180:183], v[224:227], v[244:247]
    s_waitcnt lgkmcnt(1)
    v_add_f32 v250, v250, v145
    v_fmac_f32 v251, v145, v145
    v_add_f32 v248, v248, v146
    v_mfma_f32_16x16x32_bf16 v[236:239], v[184:187], v[228:231], v[236:239]
    v_fmac_f32 v249, v146, v146
    v_add_f32 v250, v250, v147
    v_fmac_f32 v251, v147, v147
    v_mfma_f32_16x16x32_bf16 v[240:243], v[188:191], v[228:231], v[240:243]
    s_waitcnt lgkmcnt(0)
    v_add_f32 v248, v248, v250
    v_add_f32 v249, v249, v251
    s_nop 1
    v_permlane32_swap_b32 v248, v249
    v_mfma_f32_16x16x32_bf16 v[244:247], v[192:195], v[232:235], v[244:247]
    v_add_f32 v93, v248, v249
    ds_write_b32 v112, v93 offset:10240
    v_add_f32 v248, v236, v237
    v_mul_f32 v249, v236, v236
    v_add_f32 v250, v238, v239
    v_mul_f32 v251, v237, v237
    v_fmac_f32 v249, v238, v238
    v_fmac_f32 v251, v239, v239
    v_add_f32 v248, v248, v240
    v_fmac_f32 v249, v240, v240
    v_add_f32 v250, v250, v241
    v_fmac_f32 v251, v241, v241
    v_add_f32 v248, v248, v242
    v_fmac_f32 v249, v242, v242
    v_add_f32 v250, v250, v243
    v_fmac_f32 v251, v243, v243
    v_add_f32 v248, v248, v244
    v_fmac_f32 v249, v244, v244
    v_add_f32 v250, v250, v245
    v_fmac_f32 v251, v245, v245
    v_add_f32 v248, v248, v246
    v_fmac_f32 v249, v246, v246
    v_add_f32 v250, v250, v247
    v_fmac_f32 v251, v247, v247
    v_add_f32 v248, v248, v250
    v_add_f32 v249, v249, v251
    s_nop 1
    v_permlane32_swap_b32 v248, v249
    v_add_f32 v92, v248, v249
    ds_write_b32 v112, v92 offset:12288
    s_waitcnt vmcnt(0) lgkmcnt(0)
    s_barrier
    s_cmp_eq_u32 s3, 7
    s_cbranch_scc1 L_nored
    ds_read_b128 v[92:95], v111 offset:0
    ds_read_b128 v[96:99], v111 offset:1024
    s_waitcnt lgkmcnt(1)
    v_pk_add_f32 v[92:93], v[92:93], v[94:95]
    s_waitcnt lgkmcnt(0)
    v_pk_add_f32 v[96:97], v[96:97], v[98:99]
    v_pk_add_f32 v[92:93], v[92:93], v[96:97]
    v_add_f32 v92, v92, v93
    v_mul_f32 v93, 0x3baaaaab, v92
    v_mul_f32 v92, 0x3baaaaab, v92
    s_nop 1
    v_permlane32_swap_b32 v92, v93
    v_fma_f32 v93, -v92, v92, v93
    v_fma_f32 v93, |v93|, v118, v119
    v_rsq_f32 v93, v93
    s_nop 0
    v_mul_f32 v92, v92, v93
    ds_write_b64 v122, v[92:93]
L_nored:
    s_cmp_ge_u32 s3, 4
    s_cbranch_scc1 L_Q
    s_waitcnt lgkmcnt(0)
    s_barrier
    ds_read_b64 v[196:197], v121 offset:0
    ds_read_b64 v[198:199], v121 offset:256
    ds_read_b64 v[200:201], v121 offset:512
    ds_read_b64 v[202:203], v121 offset:768
    ds_read_b64 v[204:205], v121 offset:1024
    ds_read_b64 v[206:207], v121 offset:1280
    ds_read_b64 v[208:209], v121 offset:1536
    v_mov_b32 v250, v117
    v_mov_b32 v251, v252
    s_waitcnt lgkmcnt(0)
    v_pk_fma_f32 v[236:237], v[236:237], v[208:209], v[208:209] op_sel:[0,1,0] op_sel_hi:[1,1,0] neg_lo:[0,0,1] neg_hi:[0,0,1]
    v_pk_fma_f32 v[238:239], v[238:239], v[208:209], v[208:209] op_sel:[0,1,0] op_sel_hi:[1,1,0] neg_lo:[0,0,1] neg_hi:[0,0,1]
    v_pk_fma_f32 v[240:241], v[240:241], v[208:209], v[208:209] op_sel:[0,1,0] op_sel_hi:[1,1,0] neg_lo:[0,0,1] neg_hi:[0,0,1]
    v_pk_fma_f32 v[242:243], v[242:243], v[208:209], v[208:209] op_sel:[0,1,0] op_sel_hi:[1,1,0] neg_lo:[0,0,1] neg_hi:[0,0,1]
    v_pk_fma_f32 v[244:245], v[244:245], v[208:209], v[208:209] op_sel:[0,1,0] op_sel_hi:[1,1,0] neg_lo:[0,0,1] neg_hi:[0,0,1]
    v_pk_fma_f32 v[246:247], v[246:247], v[208:209], v[208:209] op_sel:[0,1,0] op_sel_hi:[1,1,0] neg_lo:[0,0,1] neg_hi:[0,0,1]
    v_cvt_pk_bf16_f32 v236, v236, v237
    v_cvt_pk_bf16_f32 v237, v238, v239
    v_cvt_pk_bf16_f32 v238, v240, v241
    v_cvt_pk_bf16_f32 v239, v242, v243
    v_cvt_pk_bf16_f32 v240, v244, v245
    v_cvt_pk_bf16_f32 v241, v246, v247
    v_pk_fma_f32 v[44:45], v[44:45], v[196:197], v[196:197] op_sel:[0,1,0] op_sel_hi:[1,1,0] neg_lo:[0,0,1] neg_hi:[0,0,1]
    v_pk_fma_f32 v[46:47], v[46:47], v[196:197], v[196:197] op_sel:[0,1,0] op_sel_hi:[1,1,0] neg_lo:[0,0,1] neg_hi:[0,0,1]
    v_pk_fma_f32 v[48:49], v[48:49], v[196:197], v[196:197] op_sel:[0,1,0] op_sel_hi:[1,1,0] neg_lo:[0,0,1] neg_hi:[0,0,1]
    v_pk_fma_f32 v[50:51], v[50:51], v[196:197], v[196:197] op_sel:[0,1,0] op_sel_hi:[1,1,0] neg_lo:[0,0,1] neg_hi:[0,0,1]
    ds_write_b64 v110, v[236:237] offset:27648
    v_pk_fma_f32 v[52:53], v[52:53], v[196:197], v[196:197] op_sel:[0,1,0] op_sel_hi:[1,1,0] neg_lo:[0,0,1] neg_hi:[0,0,1]
    v_pk_fma_f32 v[54:55], v[54:55], v[196:197], v[196:197] op_sel:[0,1,0] op_sel_hi:[1,1,0] neg_lo:[0,0,1] neg_hi:[0,0,1]
    v_cvt_pk_bf16_f32 v44, v44, v45
    v_cvt_pk_bf16_f32 v45, v46, v47
    ds_write_b64 v110, v[238:239] offset:28160
    v_cvt_pk_bf16_f32 v46, v48, v49
    v_cvt_pk_bf16_f32 v47, v50, v51
    v_cvt_pk_bf16_f32 v48, v52, v53
    v_cvt_pk_bf16_f32 v49, v54, v55
    ds_write_b64 v110, v[240:241] offset:28672
    v_pk_fma_f32 v[56:57], v[56:57], v[198:199], v[198:199] op_sel:[0,1,0] op_sel_hi:[1,1,0] neg_lo:[0,0,1] neg_hi:[0,0,1]
    v_pk_fma_f32 v[58:59], v[58:59], v[198:199], v[198:199] op_sel:[0,1,0] op_sel_hi:[1,1,0] neg_lo:[0,0,1] neg_hi:[0,0,1]
    v_pk_fma_f32 v[60:61], v[60:61], v[198:199], v[198:199] op_sel:[0,1,0] op_sel_hi:[1,1,0] neg_lo:[0,0,1] neg_hi:[0,0,1]
    v_pk_fma_f32 v[62:63], v[62:63], v[198:199], v[198:199] op_sel:[0,1,0] op_sel_hi:[1,1,0] neg_lo:[0,0,1] neg_hi:[0,0,1]
    ds_write_b64 v109, v[44:45] offset:0
    v_pk_fma_f32 v[64:65], v[64:65], v[198:199], v[198:199] op_sel:[0,1,0] op_sel_hi:[1,1,0] neg_lo:[0,0,1] neg_hi:[0,0,1]
    v_pk_fma_f32 v[66:67], v[66:67], v[198:199], v[198:199] op_sel:[0,1,0] op_sel_hi:[1,1,0] neg_lo:[0,0,1] neg_hi:[0,0,1]
    v_cvt_pk_bf16_f32 v56, v56, v57
    v_cvt_pk_bf16_f32 v57, v58, v59
    ds_write_b64 v109, v[46:47] offset:512
    v_cvt_pk_bf16_f32 v58, v60, v61
    v_cvt_pk_bf16_f32 v59, v62, v63
    v_cvt_pk_bf16_f32 v60, v64, v65
    v_cvt_pk_bf16_f32 v61, v66, v67
    ds_write_b64 v109, v[48:49] offset:1024
    v_pk_fma_f32 v[68:69], v[68:69], v[200:201], v[200:201] op_sel:[0,1,0] op_sel_hi:[1,1,0] neg_lo:[0,0,1] neg_hi:[0,0,1]
    v_pk_fma_f32 v[70:71], v[70:71], v[200:201], v[200:201] op_sel:[0,1,0] op_sel_hi:[1,1,0] neg_lo:[0,0,1] neg_hi:[0,0,1]
    v_pk_fma_f32 v[72:73], v[72:73], v[200:201], v[200:201] op_sel:[0,1,0] op_sel_hi:[1,1,0] neg_lo:[0,0,1] neg_hi:[0,0,1]
    v_pk_fma_f32 v[74:75], v[74:75], v[200:201], v[200:201] op_sel:[0,1,0] op_sel_hi:[1,1,0] neg_lo:[0,0,1] neg_hi:[0,0,1]
    ds_write_b64 v109, v[56:57] offset:13824
    v_pk_fma_f32 v[76:77], v[76:77], v[200:201], v[200:201] op_sel:[0,1,0] op_sel_hi:[1,1,0] neg_lo:[0,0,1] neg_hi:[0,0,1]
    v_pk_fma_f32 v[78:79], v[78:79], v[200:201], v[200:201] op_sel:[0,1,0] op_sel_hi:[1,1,0] neg_lo:[0,0,1] neg_hi:[0,0,1]
    v_cvt_pk_bf16_f32 v68, v68, v69
    v_cvt_pk_bf16_f32 v69, v70, v71
    ds_write_b64 v109, v[58:59] offset:14336
    v_cvt_pk_bf16_f32 v70, v72, v73
    v_cvt_pk_bf16_f32 v71, v74, v75
    v_cvt_pk_bf16_f32 v72, v76, v77
    v_cvt_pk_bf16_f32 v73, v78, v79
    ds_write_b64 v109, v[60:61] offset:14848
    v_pk_fma_f32 v[80:81], v[80:81], v[202:203], v[202:203] op_sel:[0,1,0] op_sel_hi:[1,1,0] neg_lo:[0,0,1] neg_hi:[0,0,1]
    v_pk_fma_f32 v[82:83], v[82:83], v[202:203], v[202:203] op_sel:[0,1,0] op_sel_hi:[1,1,0] neg_lo:[0,0,1] neg_hi:[0,0,1]
    v_pk_fma_f32 v[84:85], v[84:85], v[202:203], v[202:203] op_sel:[0,1,0] op_sel_hi:[1,1,0] neg_lo:[0,0,1] neg_hi:[0,0,1]
    v_pk_fma_f32 v[86:87], v[86:87], v[202:203], v[202:203] op_sel:[0,1,0] op_sel_hi:[1,1,0] neg_lo:[0,0,1] neg_hi:[0,0,1]
    ds_write_b64 v109, v[68:69] offset:27648
    v_pk_fma_f32 v[88:89], v[88:89], v[202:203], v[202:203] op_sel:[0,1,0] op_sel_hi:[1,1,0] neg_lo:[0,0,1] neg_hi:[0,0,1]
    v_pk_fma_f32 v[90:91], v[90:91], v[202:203], v[202:203] op_sel:[0,1,0] op_sel_hi:[1,1,0] neg_lo:[0,0,1] neg_hi:[0,0,1]
    v_cvt_pk_bf16_f32 v80, v80, v81
    v_cvt_pk_bf16_f32 v81, v82, v83
    ds_write_b64 v109, v[70:71] offset:28160
    v_cvt_pk_bf16_f32 v82, v84, v85
    v_cvt_pk_bf16_f32 v83, v86, v87
    v_cvt_pk_bf16_f32 v84, v88, v89
    v_cvt_pk_bf16_f32 v85, v90, v91
    ds_write_b64 v109, v[72:73] offset:28672
    v_pk_fma_f32 v[124:125], v[124:125], v[204:205], v[204:205] op_sel:[0,1,0] op_sel_hi:[1,1,0] neg_lo:[0,0,1] neg_hi:[0,0,1]
    v_pk_fma_f32 v[126:127], v[126:127], v[204:205], v[204:205] op_sel:[0,1,0] op_sel_hi:[1,1,0] neg_lo:[0,0,1] neg_hi:[0,0,1]
    v_pk_fma_f32 v[128:129], v[128:129], v[204:205], v[204:205] op_sel:[0,1,0] op_sel_hi:[1,1,0] neg_lo:[0,0,1] neg_hi:[0,0,1]
    v_pk_fma_f32 v[130:131], v[130:131], v[204:205], v[204:205] op_sel:[0,1,0] op_sel_hi:[1,1,0] neg_lo:[0,0,1] neg_hi:[0,0,1]
    ds_write_b64 v109, v[80:81] offset:41472
    v_pk_fma_f32 v[132:133], v[132:133], v[204:205], v[204:205] op_sel:[0,1,0] op_sel_hi:[1,1,0] neg_lo:[0,0,1] neg_hi:[0,0,1]
    v_pk_fma_f32 v[134:135], v[134:135], v[204:205], v[204:205] op_sel:[0,1,0] op_sel_hi:[1,1,0] neg_lo:[0,0,1] neg_hi:[0,0,1]
    v_cvt_pk_bf16_f32 v124, v124, v125
    v_cvt_pk_bf16_f32 v125, v126, v127
    ds_write_b64 v109, v[82:83] offset:41984
    v_cvt_pk_bf16_f32 v126, v128, v129
    v_cvt_pk_bf16_f32 v127, v130, v131
    v_cvt_pk_bf16_f32 v128, v132, v133
    v_cvt_pk_bf16_f32 v129, v134, v135
    ds_write_b64 v109, v[84:85] offset:42496
    v_pk_fma_f32 v[136:137], v[136:137], v[206:207], v[206:207] op_sel:[0,1,0] op_sel_hi:[1,1,0] neg_lo:[0,0,1] neg_hi:[0,0,1]
    v_pk_fma_f32 v[138:139], v[138:139], v[206:207], v[206:207] op_sel:[0,1,0] op_sel_hi:[1,1,0] neg_lo:[0,0,1] neg_hi:[0,0,1]
    v_pk_fma_f32 v[140:141], v[140:141], v[206:207], v[206:207] op_sel:[0,1,0] op_sel_hi:[1,1,0] neg_lo:[0,0,1] neg_hi:[0,0,1]
    v_pk_fma_f32 v[142:143], v[142:143], v[206:207], v[206:207] op_sel:[0,1,0] op_sel_hi:[1,1,0] neg_lo:[0,0,1] neg_hi:[0,0,1]
    ds_write_b64 v110, v[124:125] offset:0
    v_pk_fma_f32 v[144:145], v[144:145], v[206:207], v[206:207] op_sel:[0,1,0] op_sel_hi:[1,1,0] neg_lo:[0,0,1] neg_hi:[0,0,1]
    v_pk_fma_f32 v[146:147], v[146:147], v[206:207], v[206:207] op_sel:[0,1,0] op_sel_hi:[1,1,0] neg_lo:[0,0,1] neg_hi:[0,0,1]
    v_cvt_pk_bf16_f32 v136, v136, v137
    v_cvt_pk_bf16_f32 v137, v138, v139
    ds_write_b64 v110, v[126:127] offset:512
    v_cvt_pk_bf16_f32 v138, v140, v141
    v_cvt_pk_bf16_f32 v139, v142, v143
    v_cvt_pk_bf16_f32 v140, v144, v145
    v_cvt_pk_bf16_f32 v141, v146, v147
    ds_write_b64 v110, v[128:129] offset:1024
    ds_write_b64 v110, v[136:137] offset:13824
    ds_write_b64 v110, v[138:139] offset:14336
    ds_write_b64 v110, v[140:141] offset:14848
    ds_read_b64_tr_b16 v[148:149], v1 offset:0
    ds_read_b64_tr_b16 v[150:151], v1 offset:1024
    ds_read_b64_tr_b16 v[152:153], v1 offset:2048
    ds_read_b64_tr_b16 v[154:155], v1 offset:3072
    ds_read_b64_tr_b16 v[156:157], v1 offset:4096
    ds_read_b64_tr_b16 v[158:159], v1 offset:5120
    ds_read_b64_tr_b16 v[160:161], v1 offset:6144
    ds_read_b64_tr_b16 v[162:163], v1 offset:7168
    ds_read_b64_tr_b16 v[164:165], v1 offset:8192
    ds_read_b64_tr_b16 v[166:167], v1 offset:9216
    ds_read_b128 v[228:231], v2 offset:0
    ds_read_b128 v[232:235], v2 offset:32
    ds_read_b128 v[236:239], v2 offset:64
    ds_read_b128 v[240:243], v2 offset:96
    s_waitcnt lgkmcnt(14)
    s_barrier
    ds_read_b64 v[4:5], v250 offset:0
    ds_read_b64 v[6:7], v250 offset:512
    ds_read_b64 v[8:9], v250 offset:1024
    ds_read_b64 v[10:11], v250 offset:1536
    ds_read_b64 v[12:13], v250 offset:2048
    ds_read_b64 v[14:15], v250 offset:2560
    ds_read_b64 v[16:17], v250 offset:3072
    ds_read_b64 v[18:19], v250 offset:3584
    ds_read_b64 v[20:21], v250 offset:4096
    ds_read_b64 v[22:23], v250 offset:4608
    s_waitcnt lgkmcnt(8)
    v_mfma_f32_32x32x16_bf16 v[196:211], v[148:151], v[4:7], v[228:243]
    s_waitcnt lgkmcnt(6)
    ds_read_b64 v[24:25], v250 offset:5120
    ds_read_b64 v[26:27], v250 offset:5632
    ds_read_b64_tr_b16 v[168:169], v1 offset:10240
    ds_read_b64_tr_b16 v[170:171], v1 offset:11264
    v_mfma_f32_32x32x16_bf16 v[196:211], v[152:155], v[8:11], v[196:211]
    s_waitcnt lgkmcnt(8)
    ds_read_b64 v[28:29], v250 offset:6144
    ds_read_b64 v[30:31], v250 offset:6656
    ds_read_b64_tr_b16 v[172:173], v1 offset:12288
    ds_read_b64_tr_b16 v[174:175], v1 offset:13312
    v_mfma_f32_32x32x16_bf16 v[196:211], v[156:159], v[12:15], v[196:211]
    s_waitcnt lgkmcnt(10)
    ds_read_b64 v[32:33], v250 offset:7168
    ds_read_b64 v[34:35], v250 offset:7680
    ds_read_b64_tr_b16 v[176:177], v1 offset:14336
    ds_read_b64_tr_b16 v[178:179], v1 offset:15360
    v_mfma_f32_32x32x16_bf16 v[196:211], v[160:163], v[16:19], v[196:211]
    s_waitcnt lgkmcnt(12)
    ds_read_b64 v[36:37], v250 offset:8192
    ds_read_b64 v[38:39], v250 offset:8704
    ds_read_b64_tr_b16 v[180:181], v1 offset:16384
    ds_read_b64_tr_b16 v[182:183], v1 offset:17408
    v_mfma_f32_32x32x16_bf16 v[196:211], v[164:167], v[20:23], v[196:211]
    s_waitcnt lgkmcnt(12)
    ds_read_b64 v[40:41], v250 offset:9216
    ds_read_b64 v[42:43], v250 offset:9728
    ds_read_b64_tr_b16 v[184:185], v1 offset:18432
    ds_read_b64_tr_b16 v[186:187], v1 offset:19456
    v_mfma_f32_32x32x16_bf16 v[196:211], v[168:171], v[24:27], v[196:211]
    s_waitcnt lgkmcnt(12)
    ds_read_b64 v[44:45], v250 offset:10240
    ds_read_b64 v[46:47], v250 offset:10752
    ds_read_b64_tr_b16 v[188:189], v1 offset:20480
    ds_read_b64_tr_b16 v[190:191], v1 offset:21504
    v_mfma_f32_32x32x16_bf16 v[196:211], v[172:175], v[28:31], v[196:211]
    s_waitcnt lgkmcnt(12)
    ds_read_b64 v[48:49], v250 offset:11264
    ds_read_b64 v[50:51], v250 offset:11776
    ds_read_b64_tr_b16 v[192:193], v1 offset:22528
    ds_read_b64_tr_b16 v[194:195], v1 offset:23552
    v_mfma_f32_32x32x16_bf16 v[196:211], v[176:179], v[32:35], v[196:211]
    s_waitcnt lgkmcnt(12)
    v_mfma_f32_32x32x16_bf16 v[196:211], v[180:183], v[36:39], v[196:211]
    s_waitcnt lgkmcnt(8)
    v_mfma_f32_32x32x16_bf16 v[196:211], v[184:187], v[40:43], v[196:211]
    s_waitcnt lgkmcnt(4)
    v_mfma_f32_32x32x16_bf16 v[196:211], v[188:191], v[44:47], v[196:211]
    s_waitcnt lgkmcnt(0)
    v_mfma_f32_32x32x16_bf16 v[196:211], v[192:195], v[48:51], v[196:211]
    s_barrier
    ds_read_b64 v[52:53], v250 offset:27648
    ds_read_b64 v[54:55], v250 offset:28160
    ds_read_b64 v[56:57], v250 offset:28672
    ds_read_b64 v[58:59], v250 offset:29184
    ds_read_b64 v[60:61], v250 offset:29696
    ds_read_b64 v[62:63], v250 offset:30208
    ds_read_b64 v[64:65], v250 offset:30720
    ds_read_b64 v[66:67], v250 offset:31232
    s_nop 2
    v_cvt_pk_f16_f32 v252, v196, v197
    v_cvt_pk_f16_f32 v253, v198, v199
    v_cvt_pk_f16_f32 v254, v200, v201
    v_cvt_pk_f16_f32 v255, v202, v203
    v_pk_fma_f16 v244, v252, v252, s60
    v_pk_fma_f16 v245, v253, v253, s60
    ds_read_b64 v[68:69], v250 offset:31744
    ds_read_b64 v[70:71], v250 offset:32256
    ds_read_b64 v[72:73], v250 offset:32768
    ds_read_b64 v[74:75], v250 offset:33280
    ds_read_b64 v[76:77], v250 offset:33792
    ds_read_b64 v[78:79], v250 offset:34304
    ds_read_b64 v[80:81], v250 offset:34816
    ds_read_b64 v[82:83], v250 offset:35328
    v_pk_fma_f16 v246, v254, v254, s60
    v_pk_fma_f16 v247, v255, v255, s60
    v_pk_mul_f16 v252, v252, v244 neg_lo:[1,0] neg_hi:[1,0]
    v_pk_mul_f16 v253, v253, v245 neg_lo:[1,0] neg_hi:[1,0]
    v_pk_mul_f16 v254, v254, v246 neg_lo:[1,0] neg_hi:[1,0]
    v_pk_mul_f16 v255, v255, v247 neg_lo:[1,0] neg_hi:[1,0]
    ds_read_b64 v[84:85], v250 offset:35840
    ds_read_b64 v[86:87], v250 offset:36352
    ds_read_b64 v[88:89], v250 offset:36864
    ds_read_b64 v[90:91], v250 offset:37376
    ds_read_b64 v[92:93], v250 offset:37888
    ds_read_b64 v[94:95], v250 offset:38400
    ds_read_b64 v[96:97], v250 offset:38912
    ds_read_b64 v[98:99], v250 offset:39424
    v_exp_f16_sdwa v252, v252 dst_sel:WORD_0 dst_unused:UNUSED_PRESERVE src0_sel:WORD_0
    v_exp_f16_sdwa v253, v253 dst_sel:WORD_0 dst_unused:UNUSED_PRESERVE src0_sel:WORD_0
    v_exp_f16_sdwa v254, v254 dst_sel:WORD_0 dst_unused:UNUSED_PRESERVE src0_sel:WORD_0
    v_exp_f16_sdwa v255, v255 dst_sel:WORD_0 dst_unused:UNUSED_PRESERVE src0_sel:WORD_0
    v_exp_f16_sdwa v252, v252 dst_sel:WORD_1 dst_unused:UNUSED_PRESERVE src0_sel:WORD_1
    v_exp_f16_sdwa v253, v253 dst_sel:WORD_1 dst_unused:UNUSED_PRESERVE src0_sel:WORD_1
    ds_read_b64 v[100:101], v251 offset:0
    ds_read_b64 v[102:103], v251 offset:512
    ds_read_b64 v[104:105], v251 offset:1024
    ds_read_b64 v[106:107], v251 offset:1536
    ds_read_b64 v[108:109], v251 offset:2048
    ds_read_b64 v[110:111], v251 offset:2560
    ds_read_b64 v[112:113], v251 offset:3072
    ds_read_b64 v[114:115], v251 offset:3584
    v_exp_f16_sdwa v254, v254 dst_sel:WORD_1 dst_unused:UNUSED_PRESERVE src0_sel:WORD_1
    v_exp_f16_sdwa v255, v255 dst_sel:WORD_1 dst_unused:UNUSED_PRESERVE src0_sel:WORD_1
    v_pk_add_f16 v252, v252, s7
    v_pk_add_f16 v253, v253, s7
    v_pk_add_f16 v254, v254, s7
    v_pk_add_f16 v255, v255, s7
    ds_read_b64 v[116:117], v251 offset:4096
    ds_read_b64 v[118:119], v251 offset:4608
    ds_read_b64 v[120:121], v251 offset:5120
    ds_read_b64 v[122:123], v251 offset:5632
    ds_read_b64 v[124:125], v251 offset:6144
    ds_read_b64 v[126:127], v251 offset:6656
    ds_read_b64 v[128:129], v251 offset:7168
    ds_read_b64 v[130:131], v251 offset:7680
    v_rcp_f16_sdwa v252, v252 dst_sel:WORD_0 dst_unused:UNUSED_PRESERVE src0_sel:WORD_0
    v_rcp_f16_sdwa v253, v253 dst_sel:WORD_0 dst_unused:UNUSED_PRESERVE src0_sel:WORD_0
    v_rcp_f16_sdwa v254, v254 dst_sel:WORD_0 dst_unused:UNUSED_PRESERVE src0_sel:WORD_0
    v_rcp_f16_sdwa v255, v255 dst_sel:WORD_0 dst_unused:UNUSED_PRESERVE src0_sel:WORD_0
    v_rcp_f16_sdwa v252, v252 dst_sel:WORD_1 dst_unused:UNUSED_PRESERVE src0_sel:WORD_1
    v_rcp_f16_sdwa v253, v253 dst_sel:WORD_1 dst_unused:UNUSED_PRESERVE src0_sel:WORD_1
    v_rcp_f16_sdwa v254, v254 dst_sel:WORD_1 dst_unused:UNUSED_PRESERVE src0_sel:WORD_1
    ds_read_b64 v[132:133], v251 offset:8192
    ds_read_b64 v[134:135], v251 offset:8704
    ds_read_b64 v[136:137], v251 offset:9216
    ds_read_b64 v[138:139], v251 offset:9728
    ds_read_b64 v[140:141], v251 offset:10240
    ds_read_b64 v[142:143], v251 offset:10752
    ds_read_b64 v[144:145], v251 offset:11264
    ds_read_b64 v[146:147], v251 offset:11776
    v_rcp_f16_sdwa v255, v255 dst_sel:WORD_1 dst_unused:UNUSED_PRESERVE src0_sel:WORD_1
    v_fma_mix_f32 v196, v196, v252, 0 op_sel:[0,0,0] op_sel_hi:[0,1,0]
    v_fma_mix_f32 v197, v197, v252, 0 op_sel:[0,1,0] op_sel_hi:[0,1,0]
    v_fma_mix_f32 v198, v198, v253, 0 op_sel:[0,0,0] op_sel_hi:[0,1,0]
    v_fma_mix_f32 v199, v199, v253, 0 op_sel:[0,1,0] op_sel_hi:[0,1,0]
    v_fma_mix_f32 v200, v200, v254, 0 op_sel:[0,0,0] op_sel_hi:[0,1,0]
    v_fma_mix_f32 v201, v201, v254, 0 op_sel:[0,1,0] op_sel_hi:[0,1,0]
    s_mov_b32 s61, 0x10006
    s_waitcnt lgkmcnt(14)
    v_mfma_f32_32x32x16_bf16 v[212:227], v[148:151], v[52:55], v[228:243]
.p2align 6
L_Ploop:
    v_mfma_f32_32x32x16_bf16 v[212:227], v[152:155], v[56:59], v[212:227]
    s_waitcnt lgkmcnt(0)
    s_barrier
    v_fma_mix_f32 v202, v202, v255, 0 op_sel:[0,0,0] op_sel_hi:[0,1,0]
    v_fma_mix_f32 v203, v203, v255, 0 op_sel:[0,1,0] op_sel_hi:[0,1,0]
    v_mfma_f32_32x32x16_bf16 v[212:227], v[156:159], v[60:63], v[212:227]
    v_cvt_pk_bf16_f32 v244, v196, v197
    v_cvt_pk_bf16_f32 v245, v198, v199
    v_cvt_pk_bf16_f32 v246, v200, v201
    v_cvt_pk_bf16_f32 v247, v202, v203
    v_cvt_pk_f16_f32 v252, v204, v205
    v_cvt_pk_f16_f32 v253, v206, v207
    v_mfma_f32_32x32x16_bf16 v[212:227], v[160:163], v[64:67], v[212:227]
    v_cvt_pk_f16_f32 v254, v208, v209
    v_cvt_pk_f16_f32 v255, v210, v211
    v_pk_fma_f16 v248, v252, v252, s60
    v_pk_fma_f16 v249, v253, v253, s60
    v_pk_fma_f16 v250, v254, v254, s60
    v_pk_fma_f16 v251, v255, v255, s60
    v_mfma_f32_32x32x16_bf16 v[212:227], v[164:167], v[68:71], v[212:227]
    v_pk_mul_f16 v252, v252, v248 neg_lo:[1,0] neg_hi:[1,0]
    v_pk_mul_f16 v253, v253, v249 neg_lo:[1,0] neg_hi:[1,0]
    v_pk_mul_f16 v254, v254, v250 neg_lo:[1,0] neg_hi:[1,0]
    v_pk_mul_f16 v255, v255, v251 neg_lo:[1,0] neg_hi:[1,0]
    v_exp_f16_sdwa v252, v252 dst_sel:WORD_0 dst_unused:UNUSED_PRESERVE src0_sel:WORD_0
    v_mfma_f32_32x32x16_bf16 v[212:227], v[168:171], v[72:75], v[212:227]
    v_exp_f16_sdwa v253, v253 dst_sel:WORD_0 dst_unused:UNUSED_PRESERVE src0_sel:WORD_0
    v_exp_f16_sdwa v254, v254 dst_sel:WORD_0 dst_unused:UNUSED_PRESERVE src0_sel:WORD_0
    v_exp_f16_sdwa v255, v255 dst_sel:WORD_0 dst_unused:UNUSED_PRESERVE src0_sel:WORD_0
    v_mfma_f32_32x32x16_bf16 v[212:227], v[172:175], v[76:79], v[212:227]
    v_exp_f16_sdwa v252, v252 dst_sel:WORD_1 dst_unused:UNUSED_PRESERVE src0_sel:WORD_1
    v_exp_f16_sdwa v253, v253 dst_sel:WORD_1 dst_unused:UNUSED_PRESERVE src0_sel:WORD_1
    v_exp_f16_sdwa v254, v254 dst_sel:WORD_1 dst_unused:UNUSED_PRESERVE src0_sel:WORD_1
    v_mfma_f32_32x32x16_bf16 v[212:227], v[176:179], v[80:83], v[212:227]
    v_exp_f16_sdwa v255, v255 dst_sel:WORD_1 dst_unused:UNUSED_PRESERVE src0_sel:WORD_1
    v_pk_add_f16 v252, v252, s7
    v_pk_add_f16 v253, v253, s7
    v_pk_add_f16 v254, v254, s7
    v_pk_add_f16 v255, v255, s7
    v_mfma_f32_32x32x16_bf16 v[212:227], v[180:183], v[84:87], v[212:227]
    v_rcp_f16_sdwa v252, v252 dst_sel:WORD_0 dst_unused:UNUSED_PRESERVE src0_sel:WORD_0
    v_rcp_f16_sdwa v253, v253 dst_sel:WORD_0 dst_unused:UNUSED_PRESERVE src0_sel:WORD_0
    v_rcp_f16_sdwa v254, v254 dst_sel:WORD_0 dst_unused:UNUSED_PRESERVE src0_sel:WORD_0
    v_mfma_f32_32x32x16_bf16 v[212:227], v[184:187], v[88:91], v[212:227]
    v_rcp_f16_sdwa v255, v255 dst_sel:WORD_0 dst_unused:UNUSED_PRESERVE src0_sel:WORD_0
    v_rcp_f16_sdwa v252, v252 dst_sel:WORD_1 dst_unused:UNUSED_PRESERVE src0_sel:WORD_1
    v_rcp_f16_sdwa v253, v253 dst_sel:WORD_1 dst_unused:UNUSED_PRESERVE src0_sel:WORD_1
    v_mfma_f32_32x32x16_bf16 v[212:227], v[188:191], v[92:95], v[212:227]
    v_rcp_f16_sdwa v254, v254 dst_sel:WORD_1 dst_unused:UNUSED_PRESERVE src0_sel:WORD_1
    v_rcp_f16_sdwa v255, v255 dst_sel:WORD_1 dst_unused:UNUSED_PRESERVE src0_sel:WORD_1
    v_fma_mix_f32 v204, v204, v252, 0 op_sel:[0,0,0] op_sel_hi:[0,1,0]
    v_fma_mix_f32 v205, v205, v252, 0 op_sel:[0,1,0] op_sel_hi:[0,1,0]
    v_mfma_f32_32x32x16_bf16 v[212:227], v[192:195], v[96:99], v[212:227]
    ds_write_b128 v3, v[244:247] offset:0
    v_fma_mix_f32 v206, v206, v253, 0 op_sel:[0,0,0] op_sel_hi:[0,1,0]
    v_fma_mix_f32 v207, v207, v253, 0 op_sel:[0,1,0] op_sel_hi:[0,1,0]
    v_fma_mix_f32 v208, v208, v254, 0 op_sel:[0,0,0] op_sel_hi:[0,1,0]
    v_fma_mix_f32 v209, v209, v254, 0 op_sel:[0,1,0] op_sel_hi:[0,1,0]
    v_fma_mix_f32 v210, v210, v255, 0 op_sel:[0,0,0] op_sel_hi:[0,1,0]
    v_fma_mix_f32 v211, v211, v255, 0 op_sel:[0,1,0] op_sel_hi:[0,1,0]
    v_cvt_pk_bf16_f32 v248, v204, v205
    v_cvt_pk_bf16_f32 v249, v206, v207
    v_cvt_pk_bf16_f32 v250, v208, v209
    v_cvt_pk_bf16_f32 v251, v210, v211
    ds_write_b128 v3, v[248:251] offset:1024
    v_cvt_pk_f16_f32 v252, v212, v213
    v_cvt_pk_f16_f32 v253, v214, v215
    v_cvt_pk_f16_f32 v254, v216, v217
    v_cvt_pk_f16_f32 v255, v218, v219
    v_pk_fma_f16 v244, v252, v252, s60
    v_pk_fma_f16 v245, v253, v253, s60
    v_pk_fma_f16 v246, v254, v254, s60
    v_pk_fma_f16 v247, v255, v255, s60
    v_pk_mul_f16 v252, v252, v244 neg_lo:[1,0] neg_hi:[1,0]
    v_pk_mul_f16 v253, v253, v245 neg_lo:[1,0] neg_hi:[1,0]
    v_pk_mul_f16 v254, v254, v246 neg_lo:[1,0] neg_hi:[1,0]
    v_pk_mul_f16 v255, v255, v247 neg_lo:[1,0] neg_hi:[1,0]
    v_exp_f16_sdwa v252, v252 dst_sel:WORD_0 dst_unused:UNUSED_PRESERVE src0_sel:WORD_0
    v_exp_f16_sdwa v253, v253 dst_sel:WORD_0 dst_unused:UNUSED_PRESERVE src0_sel:WORD_0
    v_exp_f16_sdwa v254, v254 dst_sel:WORD_0 dst_unused:UNUSED_PRESERVE src0_sel:WORD_0
    v_exp_f16_sdwa v255, v255 dst_sel:WORD_0 dst_unused:UNUSED_PRESERVE src0_sel:WORD_0
    v_exp_f16_sdwa v252, v252 dst_sel:WORD_1 dst_unused:UNUSED_PRESERVE src0_sel:WORD_1
    v_exp_f16_sdwa v253, v253 dst_sel:WORD_1 dst_unused:UNUSED_PRESERVE src0_sel:WORD_1
    v_exp_f16_sdwa v254, v254 dst_sel:WORD_1 dst_unused:UNUSED_PRESERVE src0_sel:WORD_1
    v_exp_f16_sdwa v255, v255 dst_sel:WORD_1 dst_unused:UNUSED_PRESERVE src0_sel:WORD_1
    v_pk_add_f16 v252, v252, s7
    v_pk_add_f16 v253, v253, s7
    v_pk_add_f16 v254, v254, s7
    v_pk_add_f16 v255, v255, s7
    v_rcp_f16_sdwa v252, v252 dst_sel:WORD_0 dst_unused:UNUSED_PRESERVE src0_sel:WORD_0
    v_rcp_f16_sdwa v253, v253 dst_sel:WORD_0 dst_unused:UNUSED_PRESERVE src0_sel:WORD_0
    v_rcp_f16_sdwa v254, v254 dst_sel:WORD_0 dst_unused:UNUSED_PRESERVE src0_sel:WORD_0
    v_rcp_f16_sdwa v255, v255 dst_sel:WORD_0 dst_unused:UNUSED_PRESERVE src0_sel:WORD_0
    v_rcp_f16_sdwa v252, v252 dst_sel:WORD_1 dst_unused:UNUSED_PRESERVE src0_sel:WORD_1
    v_rcp_f16_sdwa v253, v253 dst_sel:WORD_1 dst_unused:UNUSED_PRESERVE src0_sel:WORD_1
    v_rcp_f16_sdwa v254, v254 dst_sel:WORD_1 dst_unused:UNUSED_PRESERVE src0_sel:WORD_1
    v_rcp_f16_sdwa v255, v255 dst_sel:WORD_1 dst_unused:UNUSED_PRESERVE src0_sel:WORD_1
    v_fma_mix_f32 v212, v212, v252, 0 op_sel:[0,0,0] op_sel_hi:[0,1,0]
    v_fma_mix_f32 v213, v213, v252, 0 op_sel:[0,1,0] op_sel_hi:[0,1,0]
    v_fma_mix_f32 v214, v214, v253, 0 op_sel:[0,0,0] op_sel_hi:[0,1,0]
    v_fma_mix_f32 v215, v215, v253, 0 op_sel:[0,1,0] op_sel_hi:[0,1,0]
    v_fma_mix_f32 v216, v216, v254, 0 op_sel:[0,0,0] op_sel_hi:[0,1,0]
    v_fma_mix_f32 v217, v217, v254, 0 op_sel:[0,1,0] op_sel_hi:[0,1,0]
    v_fma_mix_f32 v218, v218, v255, 0 op_sel:[0,0,0] op_sel_hi:[0,1,0]
    v_fma_mix_f32 v219, v219, v255, 0 op_sel:[0,1,0] op_sel_hi:[0,1,0]
    v_cvt_pk_bf16_f32 v244, v212, v213
    v_cvt_pk_bf16_f32 v245, v214, v215
    v_cvt_pk_bf16_f32 v246, v216, v217
    v_cvt_pk_bf16_f32 v247, v218, v219
    v_cvt_pk_f16_f32 v252, v220, v221
    v_cvt_pk_f16_f32 v253, v222, v223
    v_cvt_pk_f16_f32 v254, v224, v225
    v_cvt_pk_f16_f32 v255, v226, v227
    v_pk_fma_f16 v248, v252, v252, s60
    v_pk_fma_f16 v249, v253, v253, s60
    v_pk_fma_f16 v250, v254, v254, s60
    v_pk_fma_f16 v251, v255, v255, s60
    v_pk_mul_f16 v252, v252, v248 neg_lo:[1,0] neg_hi:[1,0]
    v_pk_mul_f16 v253, v253, v249 neg_lo:[1,0] neg_hi:[1,0]
    v_pk_mul_f16 v254, v254, v250 neg_lo:[1,0] neg_hi:[1,0]
    v_pk_mul_f16 v255, v255, v251 neg_lo:[1,0] neg_hi:[1,0]
    v_exp_f16_sdwa v252, v252 dst_sel:WORD_0 dst_unused:UNUSED_PRESERVE src0_sel:WORD_0
    v_exp_f16_sdwa v253, v253 dst_sel:WORD_0 dst_unused:UNUSED_PRESERVE src0_sel:WORD_0
    v_exp_f16_sdwa v254, v254 dst_sel:WORD_0 dst_unused:UNUSED_PRESERVE src0_sel:WORD_0
    v_mfma_f32_32x32x16_bf16 v[196:211], v[148:151], v[100:103], v[228:243]
    ds_read_b64_tr_b16 v[148:149], v1 offset:24576
    ds_read_b64_tr_b16 v[150:151], v1 offset:25600
    v_exp_f16_sdwa v255, v255 dst_sel:WORD_0 dst_unused:UNUSED_PRESERVE src0_sel:WORD_0
    v_mfma_f32_32x32x16_bf16 v[196:211], v[152:155], v[104:107], v[196:211]
    ds_read_b64_tr_b16 v[152:153], v1 offset:26624
    ds_read_b64_tr_b16 v[154:155], v1 offset:27648
    v_exp_f16_sdwa v252, v252 dst_sel:WORD_1 dst_unused:UNUSED_PRESERVE src0_sel:WORD_1
    v_exp_f16_sdwa v253, v253 dst_sel:WORD_1 dst_unused:UNUSED_PRESERVE src0_sel:WORD_1
    v_mfma_f32_32x32x16_bf16 v[196:211], v[156:159], v[108:111], v[196:211]
    ds_read_b64_tr_b16 v[156:157], v1 offset:28672
    ds_read_b64_tr_b16 v[158:159], v1 offset:29696
    v_exp_f16_sdwa v254, v254 dst_sel:WORD_1 dst_unused:UNUSED_PRESERVE src0_sel:WORD_1
    v_mfma_f32_32x32x16_bf16 v[196:211], v[160:163], v[112:115], v[196:211]
    ds_read_b64_tr_b16 v[160:161], v1 offset:30720
    ds_read_b64_tr_b16 v[162:163], v1 offset:31744
    v_exp_f16_sdwa v255, v255 dst_sel:WORD_1 dst_unused:UNUSED_PRESERVE src0_sel:WORD_1
    v_mfma_f32_32x32x16_bf16 v[196:211], v[164:167], v[116:119], v[196:211]
    ds_read_b64_tr_b16 v[164:165], v1 offset:32768
    ds_read_b64_tr_b16 v[166:167], v1 offset:33792
    v_pk_add_f16 v252, v252, s7
    v_pk_add_f16 v253, v253, s7
    v_pk_add_f16 v254, v254, s7
    v_pk_add_f16 v255, v255, s7
    v_mfma_f32_32x32x16_bf16 v[196:211], v[168:171], v[120:123], v[196:211]
    ds_read_b64_tr_b16 v[168:169], v1 offset:34816
    ds_read_b64_tr_b16 v[170:171], v1 offset:35840
    v_rcp_f16_sdwa v252, v252 dst_sel:WORD_0 dst_unused:UNUSED_PRESERVE src0_sel:WORD_0
    v_rcp_f16_sdwa v253, v253 dst_sel:WORD_0 dst_unused:UNUSED_PRESERVE src0_sel:WORD_0
    v_mfma_f32_32x32x16_bf16 v[196:211], v[172:175], v[124:127], v[196:211]
    ds_read_b64_tr_b16 v[172:173], v1 offset:36864
    ds_read_b64_tr_b16 v[174:175], v1 offset:37888
    v_rcp_f16_sdwa v254, v254 dst_sel:WORD_0 dst_unused:UNUSED_PRESERVE src0_sel:WORD_0
    v_mfma_f32_32x32x16_bf16 v[196:211], v[176:179], v[128:131], v[196:211]
    ds_read_b64_tr_b16 v[176:177], v1 offset:38912
    ds_read_b64_tr_b16 v[178:179], v1 offset:39936
    v_rcp_f16_sdwa v255, v255 dst_sel:WORD_0 dst_unused:UNUSED_PRESERVE src0_sel:WORD_0
    v_mfma_f32_32x32x16_bf16 v[196:211], v[180:183], v[132:135], v[196:211]
    ds_read_b64_tr_b16 v[180:181], v1 offset:40960
    ds_read_b64_tr_b16 v[182:183], v1 offset:41984
    v_rcp_f16_sdwa v252, v252 dst_sel:WORD_1 dst_unused:UNUSED_PRESERVE src0_sel:WORD_1
    v_rcp_f16_sdwa v253, v253 dst_sel:WORD_1 dst_unused:UNUSED_PRESERVE src0_sel:WORD_1
    v_mfma_f32_32x32x16_bf16 v[196:211], v[184:187], v[136:139], v[196:211]
    ds_read_b64_tr_b16 v[184:185], v1 offset:43008
    ds_read_b64_tr_b16 v[186:187], v1 offset:44032
    v_rcp_f16_sdwa v254, v254 dst_sel:WORD_1 dst_unused:UNUSED_PRESERVE src0_sel:WORD_1
    v_rcp_f16_sdwa v255, v255 dst_sel:WORD_1 dst_unused:UNUSED_PRESERVE src0_sel:WORD_1
    v_mfma_f32_32x32x16_bf16 v[196:211], v[188:191], v[140:143], v[196:211]
    ds_read_b64_tr_b16 v[188:189], v1 offset:45056
    ds_read_b64_tr_b16 v[190:191], v1 offset:46080
    v_fma_mix_f32 v220, v220, v252, 0 op_sel:[0,0,0] op_sel_hi:[0,1,0]
    v_fma_mix_f32 v221, v221, v252, 0 op_sel:[0,1,0] op_sel_hi:[0,1,0]
    v_mfma_f32_32x32x16_bf16 v[196:211], v[192:195], v[144:147], v[196:211]
    ds_read_b64_tr_b16 v[192:193], v1 offset:47104
    ds_read_b64_tr_b16 v[194:195], v1 offset:48128
    ds_write_b128 v3, v[244:247] offset:4096
    ds_read_b128 v[228:231], v2 offset:256
    ds_read_b128 v[232:235], v2 offset:288
    v_fma_mix_f32 v222, v222, v253, 0 op_sel:[0,0,0] op_sel_hi:[0,1,0]
    v_fma_mix_f32 v223, v223, v253, 0 op_sel:[0,1,0] op_sel_hi:[0,1,0]
    v_fma_mix_f32 v224, v224, v254, 0 op_sel:[0,0,0] op_sel_hi:[0,1,0]
    v_fma_mix_f32 v225, v225, v254, 0 op_sel:[0,1,0] op_sel_hi:[0,1,0]
    v_fma_mix_f32 v226, v226, v255, 0 op_sel:[0,0,0] op_sel_hi:[0,1,0]
    v_fma_mix_f32 v227, v227, v255, 0 op_sel:[0,1,0] op_sel_hi:[0,1,0]
    v_cvt_pk_bf16_f32 v248, v220, v221
    v_cvt_pk_bf16_f32 v249, v222, v223
    v_cvt_pk_bf16_f32 v250, v224, v225
    v_cvt_pk_bf16_f32 v251, v226, v227
    ds_write_b128 v3, v[248:251] offset:5120
    ds_read_b128 v[236:239], v2 offset:320
    ds_read_b128 v[240:243], v2 offset:352
    v_cvt_pk_f16_f32 v252, v196, v197
    v_cvt_pk_f16_f32 v253, v198, v199
    v_cvt_pk_f16_f32 v254, v200, v201
    v_cvt_pk_f16_f32 v255, v202, v203
    v_pk_fma_f16 v244, v252, v252, s60
    v_pk_fma_f16 v245, v253, v253, s60
    v_pk_fma_f16 v246, v254, v254, s60
    v_pk_fma_f16 v247, v255, v255, s60
    v_pk_mul_f16 v252, v252, v244 neg_lo:[1,0] neg_hi:[1,0]
    v_pk_mul_f16 v253, v253, v245 neg_lo:[1,0] neg_hi:[1,0]
    v_pk_mul_f16 v254, v254, v246 neg_lo:[1,0] neg_hi:[1,0]
    v_pk_mul_f16 v255, v255, v247 neg_lo:[1,0] neg_hi:[1,0]
    v_exp_f16_sdwa v252, v252 dst_sel:WORD_0 dst_unused:UNUSED_PRESERVE src0_sel:WORD_0
    v_exp_f16_sdwa v253, v253 dst_sel:WORD_0 dst_unused:UNUSED_PRESERVE src0_sel:WORD_0
    v_exp_f16_sdwa v254, v254 dst_sel:WORD_0 dst_unused:UNUSED_PRESERVE src0_sel:WORD_0
    v_exp_f16_sdwa v255, v255 dst_sel:WORD_0 dst_unused:UNUSED_PRESERVE src0_sel:WORD_0
    v_exp_f16_sdwa v252, v252 dst_sel:WORD_1 dst_unused:UNUSED_PRESERVE src0_sel:WORD_1
    v_exp_f16_sdwa v253, v253 dst_sel:WORD_1 dst_unused:UNUSED_PRESERVE src0_sel:WORD_1
    v_exp_f16_sdwa v254, v254 dst_sel:WORD_1 dst_unused:UNUSED_PRESERVE src0_sel:WORD_1
    v_exp_f16_sdwa v255, v255 dst_sel:WORD_1 dst_unused:UNUSED_PRESERVE src0_sel:WORD_1
    v_pk_add_f16 v252, v252, s7
    v_pk_add_f16 v253, v253, s7
    v_pk_add_f16 v254, v254, s7
    v_pk_add_f16 v255, v255, s7
    v_rcp_f16_sdwa v252, v252 dst_sel:WORD_0 dst_unused:UNUSED_PRESERVE src0_sel:WORD_0
    v_rcp_f16_sdwa v253, v253 dst_sel:WORD_0 dst_unused:UNUSED_PRESERVE src0_sel:WORD_0
    v_rcp_f16_sdwa v254, v254 dst_sel:WORD_0 dst_unused:UNUSED_PRESERVE src0_sel:WORD_0
    v_rcp_f16_sdwa v255, v255 dst_sel:WORD_0 dst_unused:UNUSED_PRESERVE src0_sel:WORD_0
    v_rcp_f16_sdwa v252, v252 dst_sel:WORD_1 dst_unused:UNUSED_PRESERVE src0_sel:WORD_1
    v_rcp_f16_sdwa v253, v253 dst_sel:WORD_1 dst_unused:UNUSED_PRESERVE src0_sel:WORD_1
    s_waitcnt lgkmcnt(0)
    s_sub_u32 s61, s61, 1
    v_mfma_f32_32x32x16_bf16 v[212:227], v[148:151], v[4:7], v[228:243]
    v_rcp_f16_sdwa v254, v254 dst_sel:WORD_1 dst_unused:UNUSED_PRESERVE src0_sel:WORD_1
    v_rcp_f16_sdwa v255, v255 dst_sel:WORD_1 dst_unused:UNUSED_PRESERVE src0_sel:WORD_1
    v_fma_mix_f32 v196, v196, v252, 0 op_sel:[0,0,0] op_sel_hi:[0,1,0]
    v_fma_mix_f32 v197, v197, v252, 0 op_sel:[0,1,0] op_sel_hi:[0,1,0]
    v_mfma_f32_32x32x16_bf16 v[212:227], v[152:155], v[8:11], v[212:227]
    v_fma_mix_f32 v198, v198, v253, 0 op_sel:[0,0,0] op_sel_hi:[0,1,0]
    v_fma_mix_f32 v199, v199, v253, 0 op_sel:[0,1,0] op_sel_hi:[0,1,0]
    v_fma_mix_f32 v200, v200, v254, 0 op_sel:[0,0,0] op_sel_hi:[0,1,0]
    v_fma_mix_f32 v201, v201, v254, 0 op_sel:[0,1,0] op_sel_hi:[0,1,0]
    v_fma_mix_f32 v202, v202, v255, 0 op_sel:[0,0,0] op_sel_hi:[0,1,0]
    v_fma_mix_f32 v203, v203, v255, 0 op_sel:[0,1,0] op_sel_hi:[0,1,0]
    v_mfma_f32_32x32x16_bf16 v[212:227], v[156:159], v[12:15], v[212:227]
    v_cvt_pk_bf16_f32 v244, v196, v197
    v_cvt_pk_bf16_f32 v245, v198, v199
    v_cvt_pk_bf16_f32 v246, v200, v201
    v_cvt_pk_bf16_f32 v247, v202, v203
    v_cvt_pk_f16_f32 v252, v204, v205
    v_cvt_pk_f16_f32 v253, v206, v207
    v_mfma_f32_32x32x16_bf16 v[212:227], v[160:163], v[16:19], v[212:227]
    v_cvt_pk_f16_f32 v254, v208, v209
    v_cvt_pk_f16_f32 v255, v210, v211
    v_pk_fma_f16 v248, v252, v252, s60
    v_pk_fma_f16 v249, v253, v253, s60
    v_pk_fma_f16 v250, v254, v254, s60
    v_pk_fma_f16 v251, v255, v255, s60
    v_mfma_f32_32x32x16_bf16 v[212:227], v[164:167], v[20:23], v[212:227]
    v_pk_mul_f16 v252, v252, v248 neg_lo:[1,0] neg_hi:[1,0]
    v_pk_mul_f16 v253, v253, v249 neg_lo:[1,0] neg_hi:[1,0]
    v_pk_mul_f16 v254, v254, v250 neg_lo:[1,0] neg_hi:[1,0]
    v_pk_mul_f16 v255, v255, v251 neg_lo:[1,0] neg_hi:[1,0]
    v_exp_f16_sdwa v252, v252 dst_sel:WORD_0 dst_unused:UNUSED_PRESERVE src0_sel:WORD_0
    v_mfma_f32_32x32x16_bf16 v[212:227], v[168:171], v[24:27], v[212:227]
    v_exp_f16_sdwa v253, v253 dst_sel:WORD_0 dst_unused:UNUSED_PRESERVE src0_sel:WORD_0
    v_exp_f16_sdwa v254, v254 dst_sel:WORD_0 dst_unused:UNUSED_PRESERVE src0_sel:WORD_0
    v_exp_f16_sdwa v255, v255 dst_sel:WORD_0 dst_unused:UNUSED_PRESERVE src0_sel:WORD_0
    v_mfma_f32_32x32x16_bf16 v[212:227], v[172:175], v[28:31], v[212:227]
    v_exp_f16_sdwa v252, v252 dst_sel:WORD_1 dst_unused:UNUSED_PRESERVE src0_sel:WORD_1
    v_exp_f16_sdwa v253, v253 dst_sel:WORD_1 dst_unused:UNUSED_PRESERVE src0_sel:WORD_1
    v_exp_f16_sdwa v254, v254 dst_sel:WORD_1 dst_unused:UNUSED_PRESERVE src0_sel:WORD_1
    v_mfma_f32_32x32x16_bf16 v[212:227], v[176:179], v[32:35], v[212:227]
    v_exp_f16_sdwa v255, v255 dst_sel:WORD_1 dst_unused:UNUSED_PRESERVE src0_sel:WORD_1
    v_pk_add_f16 v252, v252, s7
    v_pk_add_f16 v253, v253, s7
    v_pk_add_f16 v254, v254, s7
    v_pk_add_f16 v255, v255, s7
    v_mfma_f32_32x32x16_bf16 v[212:227], v[180:183], v[36:39], v[212:227]
    v_rcp_f16_sdwa v252, v252 dst_sel:WORD_0 dst_unused:UNUSED_PRESERVE src0_sel:WORD_0
    v_rcp_f16_sdwa v253, v253 dst_sel:WORD_0 dst_unused:UNUSED_PRESERVE src0_sel:WORD_0
    v_rcp_f16_sdwa v254, v254 dst_sel:WORD_0 dst_unused:UNUSED_PRESERVE src0_sel:WORD_0
    v_mfma_f32_32x32x16_bf16 v[212:227], v[184:187], v[40:43], v[212:227]
    v_rcp_f16_sdwa v255, v255 dst_sel:WORD_0 dst_unused:UNUSED_PRESERVE src0_sel:WORD_0
    v_rcp_f16_sdwa v252, v252 dst_sel:WORD_1 dst_unused:UNUSED_PRESERVE src0_sel:WORD_1
    v_rcp_f16_sdwa v253, v253 dst_sel:WORD_1 dst_unused:UNUSED_PRESERVE src0_sel:WORD_1
    v_mfma_f32_32x32x16_bf16 v[212:227], v[188:191], v[44:47], v[212:227]
    v_rcp_f16_sdwa v254, v254 dst_sel:WORD_1 dst_unused:UNUSED_PRESERVE src0_sel:WORD_1
    v_rcp_f16_sdwa v255, v255 dst_sel:WORD_1 dst_unused:UNUSED_PRESERVE src0_sel:WORD_1
    v_fma_mix_f32 v204, v204, v252, 0 op_sel:[0,0,0] op_sel_hi:[0,1,0]
    v_fma_mix_f32 v205, v205, v252, 0 op_sel:[0,1,0] op_sel_hi:[0,1,0]
    v_mfma_f32_32x32x16_bf16 v[212:227], v[192:195], v[48:51], v[212:227]
    ds_write_b128 v3, v[244:247] offset:8192
    v_fma_mix_f32 v206, v206, v253, 0 op_sel:[0,0,0] op_sel_hi:[0,1,0]
    v_fma_mix_f32 v207, v207, v253, 0 op_sel:[0,1,0] op_sel_hi:[0,1,0]
    v_fma_mix_f32 v208, v208, v254, 0 op_sel:[0,0,0] op_sel_hi:[0,1,0]
    v_fma_mix_f32 v209, v209, v254, 0 op_sel:[0,1,0] op_sel_hi:[0,1,0]
    v_fma_mix_f32 v210, v210, v255, 0 op_sel:[0,0,0] op_sel_hi:[0,1,0]
    v_fma_mix_f32 v211, v211, v255, 0 op_sel:[0,1,0] op_sel_hi:[0,1,0]
    v_cvt_pk_bf16_f32 v248, v204, v205
    v_cvt_pk_bf16_f32 v249, v206, v207
    v_cvt_pk_bf16_f32 v250, v208, v209
    v_cvt_pk_bf16_f32 v251, v210, v211
    ds_write_b128 v3, v[248:251] offset:9216
    v_cvt_pk_f16_f32 v252, v212, v213
    v_cvt_pk_f16_f32 v253, v214, v215
    v_cvt_pk_f16_f32 v254, v216, v217
    v_cvt_pk_f16_f32 v255, v218, v219
    v_pk_fma_f16 v244, v252, v252, s60
    v_pk_fma_f16 v245, v253, v253, s60
    v_pk_fma_f16 v246, v254, v254, s60
    v_pk_fma_f16 v247, v255, v255, s60
    v_pk_mul_f16 v252, v252, v244 neg_lo:[1,0] neg_hi:[1,0]
    v_pk_mul_f16 v253, v253, v245 neg_lo:[1,0] neg_hi:[1,0]
    v_pk_mul_f16 v254, v254, v246 neg_lo:[1,0] neg_hi:[1,0]
    v_pk_mul_f16 v255, v255, v247 neg_lo:[1,0] neg_hi:[1,0]
    v_exp_f16_sdwa v252, v252 dst_sel:WORD_0 dst_unused:UNUSED_PRESERVE src0_sel:WORD_0
    v_exp_f16_sdwa v253, v253 dst_sel:WORD_0 dst_unused:UNUSED_PRESERVE src0_sel:WORD_0
    v_exp_f16_sdwa v254, v254 dst_sel:WORD_0 dst_unused:UNUSED_PRESERVE src0_sel:WORD_0
    v_exp_f16_sdwa v255, v255 dst_sel:WORD_0 dst_unused:UNUSED_PRESERVE src0_sel:WORD_0
    v_exp_f16_sdwa v252, v252 dst_sel:WORD_1 dst_unused:UNUSED_PRESERVE src0_sel:WORD_1
    v_exp_f16_sdwa v253, v253 dst_sel:WORD_1 dst_unused:UNUSED_PRESERVE src0_sel:WORD_1
    v_exp_f16_sdwa v254, v254 dst_sel:WORD_1 dst_unused:UNUSED_PRESERVE src0_sel:WORD_1
    v_exp_f16_sdwa v255, v255 dst_sel:WORD_1 dst_unused:UNUSED_PRESERVE src0_sel:WORD_1
    v_pk_add_f16 v252, v252, s7
    v_pk_add_f16 v253, v253, s7
    v_pk_add_f16 v254, v254, s7
    v_pk_add_f16 v255, v255, s7
    v_rcp_f16_sdwa v252, v252 dst_sel:WORD_0 dst_unused:UNUSED_PRESERVE src0_sel:WORD_0
    v_rcp_f16_sdwa v253, v253 dst_sel:WORD_0 dst_unused:UNUSED_PRESERVE src0_sel:WORD_0
    v_rcp_f16_sdwa v254, v254 dst_sel:WORD_0 dst_unused:UNUSED_PRESERVE src0_sel:WORD_0
    v_rcp_f16_sdwa v255, v255 dst_sel:WORD_0 dst_unused:UNUSED_PRESERVE src0_sel:WORD_0
    v_rcp_f16_sdwa v252, v252 dst_sel:WORD_1 dst_unused:UNUSED_PRESERVE src0_sel:WORD_1
    v_rcp_f16_sdwa v253, v253 dst_sel:WORD_1 dst_unused:UNUSED_PRESERVE src0_sel:WORD_1
    v_rcp_f16_sdwa v254, v254 dst_sel:WORD_1 dst_unused:UNUSED_PRESERVE src0_sel:WORD_1
    v_rcp_f16_sdwa v255, v255 dst_sel:WORD_1 dst_unused:UNUSED_PRESERVE src0_sel:WORD_1
    v_add_u32 v2, 512, v2
    v_mfma_f32_32x32x16_bf16 v[196:211], v[148:151], v[52:55], v[228:243]
    v_fma_mix_f32 v212, v212, v252, 0 op_sel:[0,0,0] op_sel_hi:[0,1,0]
    v_fma_mix_f32 v213, v213, v252, 0 op_sel:[0,1,0] op_sel_hi:[0,1,0]
    v_fma_mix_f32 v214, v214, v253, 0 op_sel:[0,0,0] op_sel_hi:[0,1,0]
    v_fma_mix_f32 v215, v215, v253, 0 op_sel:[0,1,0] op_sel_hi:[0,1,0]
    v_fma_mix_f32 v216, v216, v254, 0 op_sel:[0,0,0] op_sel_hi:[0,1,0]
    v_fma_mix_f32 v217, v217, v254, 0 op_sel:[0,1,0] op_sel_hi:[0,1,0]
    v_mfma_f32_32x32x16_bf16 v[196:211], v[152:155], v[56:59], v[196:211]
    s_waitcnt lgkmcnt(0)
    s_barrier
    v_fma_mix_f32 v218, v218, v255, 0 op_sel:[0,0,0] op_sel_hi:[0,1,0]
    v_fma_mix_f32 v219, v219, v255, 0 op_sel:[0,1,0] op_sel_hi:[0,1,0]
    v_mfma_f32_32x32x16_bf16 v[196:211], v[156:159], v[60:63], v[196:211]
    v_cvt_pk_bf16_f32 v244, v212, v213
    v_cvt_pk_bf16_f32 v245, v214, v215
    v_cvt_pk_bf16_f32 v246, v216, v217
    v_cvt_pk_bf16_f32 v247, v218, v219
    v_cvt_pk_f16_f32 v252, v220, v221
    v_cvt_pk_f16_f32 v253, v222, v223
    v_mfma_f32_32x32x16_bf16 v[196:211], v[160:163], v[64:67], v[196:211]
    v_cvt_pk_f16_f32 v254, v224, v225
    v_cvt_pk_f16_f32 v255, v226, v227
    v_pk_fma_f16 v248, v252, v252, s60
    v_pk_fma_f16 v249, v253, v253, s60
    v_pk_fma_f16 v250, v254, v254, s60
    v_pk_fma_f16 v251, v255, v255, s60
    v_mfma_f32_32x32x16_bf16 v[196:211], v[164:167], v[68:71], v[196:211]
    v_pk_mul_f16 v252, v252, v248 neg_lo:[1,0] neg_hi:[1,0]
    v_pk_mul_f16 v253, v253, v249 neg_lo:[1,0] neg_hi:[1,0]
    v_pk_mul_f16 v254, v254, v250 neg_lo:[1,0] neg_hi:[1,0]
    v_pk_mul_f16 v255, v255, v251 neg_lo:[1,0] neg_hi:[1,0]
    v_exp_f16_sdwa v252, v252 dst_sel:WORD_0 dst_unused:UNUSED_PRESERVE src0_sel:WORD_0
    v_mfma_f32_32x32x16_bf16 v[196:211], v[168:171], v[72:75], v[196:211]
    v_exp_f16_sdwa v253, v253 dst_sel:WORD_0 dst_unused:UNUSED_PRESERVE src0_sel:WORD_0
    v_exp_f16_sdwa v254, v254 dst_sel:WORD_0 dst_unused:UNUSED_PRESERVE src0_sel:WORD_0
    v_exp_f16_sdwa v255, v255 dst_sel:WORD_0 dst_unused:UNUSED_PRESERVE src0_sel:WORD_0
    v_mfma_f32_32x32x16_bf16 v[196:211], v[172:175], v[76:79], v[196:211]
    v_exp_f16_sdwa v252, v252 dst_sel:WORD_1 dst_unused:UNUSED_PRESERVE src0_sel:WORD_1
    v_exp_f16_sdwa v253, v253 dst_sel:WORD_1 dst_unused:UNUSED_PRESERVE src0_sel:WORD_1
    v_exp_f16_sdwa v254, v254 dst_sel:WORD_1 dst_unused:UNUSED_PRESERVE src0_sel:WORD_1
    v_mfma_f32_32x32x16_bf16 v[196:211], v[176:179], v[80:83], v[196:211]
    v_exp_f16_sdwa v255, v255 dst_sel:WORD_1 dst_unused:UNUSED_PRESERVE src0_sel:WORD_1
    v_pk_add_f16 v252, v252, s7
    v_pk_add_f16 v253, v253, s7
    v_pk_add_f16 v254, v254, s7
    v_pk_add_f16 v255, v255, s7
    v_mfma_f32_32x32x16_bf16 v[196:211], v[180:183], v[84:87], v[196:211]
    v_rcp_f16_sdwa v252, v252 dst_sel:WORD_0 dst_unused:UNUSED_PRESERVE src0_sel:WORD_0
    v_rcp_f16_sdwa v253, v253 dst_sel:WORD_0 dst_unused:UNUSED_PRESERVE src0_sel:WORD_0
    v_rcp_f16_sdwa v254, v254 dst_sel:WORD_0 dst_unused:UNUSED_PRESERVE src0_sel:WORD_0
    v_mfma_f32_32x32x16_bf16 v[196:211], v[184:187], v[88:91], v[196:211]
    v_rcp_f16_sdwa v255, v255 dst_sel:WORD_0 dst_unused:UNUSED_PRESERVE src0_sel:WORD_0
    v_rcp_f16_sdwa v252, v252 dst_sel:WORD_1 dst_unused:UNUSED_PRESERVE src0_sel:WORD_1
    v_rcp_f16_sdwa v253, v253 dst_sel:WORD_1 dst_unused:UNUSED_PRESERVE src0_sel:WORD_1
    v_mfma_f32_32x32x16_bf16 v[196:211], v[188:191], v[92:95], v[196:211]
    v_rcp_f16_sdwa v254, v254 dst_sel:WORD_1 dst_unused:UNUSED_PRESERVE src0_sel:WORD_1
    v_rcp_f16_sdwa v255, v255 dst_sel:WORD_1 dst_unused:UNUSED_PRESERVE src0_sel:WORD_1
    v_fma_mix_f32 v220, v220, v252, 0 op_sel:[0,0,0] op_sel_hi:[0,1,0]
    v_fma_mix_f32 v221, v221, v252, 0 op_sel:[0,1,0] op_sel_hi:[0,1,0]
    v_mfma_f32_32x32x16_bf16 v[196:211], v[192:195], v[96:99], v[196:211]
    ds_write_b128 v3, v[244:247] offset:24576
    v_fma_mix_f32 v222, v222, v253, 0 op_sel:[0,0,0] op_sel_hi:[0,1,0]
    v_fma_mix_f32 v223, v223, v253, 0 op_sel:[0,1,0] op_sel_hi:[0,1,0]
    v_fma_mix_f32 v224, v224, v254, 0 op_sel:[0,0,0] op_sel_hi:[0,1,0]
    v_fma_mix_f32 v225, v225, v254, 0 op_sel:[0,1,0] op_sel_hi:[0,1,0]
    v_fma_mix_f32 v226, v226, v255, 0 op_sel:[0,0,0] op_sel_hi:[0,1,0]
    v_fma_mix_f32 v227, v227, v255, 0 op_sel:[0,1,0] op_sel_hi:[0,1,0]
    v_cvt_pk_bf16_f32 v248, v220, v221
    v_cvt_pk_bf16_f32 v249, v222, v223
    v_cvt_pk_bf16_f32 v250, v224, v225
    v_cvt_pk_bf16_f32 v251, v226, v227
    ds_write_b128 v3, v[248:251] offset:25600
    v_cvt_pk_f16_f32 v252, v196, v197
    v_cvt_pk_f16_f32 v253, v198, v199
    v_cvt_pk_f16_f32 v254, v200, v201
    v_cvt_pk_f16_f32 v255, v202, v203
    v_pk_fma_f16 v244, v252, v252, s60
    v_pk_fma_f16 v245, v253, v253, s60
    v_pk_fma_f16 v246, v254, v254, s60
    v_pk_fma_f16 v247, v255, v255, s60
    v_pk_mul_f16 v252, v252, v244 neg_lo:[1,0] neg_hi:[1,0]
    v_pk_mul_f16 v253, v253, v245 neg_lo:[1,0] neg_hi:[1,0]
    v_pk_mul_f16 v254, v254, v246 neg_lo:[1,0] neg_hi:[1,0]
    v_pk_mul_f16 v255, v255, v247 neg_lo:[1,0] neg_hi:[1,0]
    v_exp_f16_sdwa v252, v252 dst_sel:WORD_0 dst_unused:UNUSED_PRESERVE src0_sel:WORD_0
    v_exp_f16_sdwa v253, v253 dst_sel:WORD_0 dst_unused:UNUSED_PRESERVE src0_sel:WORD_0
    v_exp_f16_sdwa v254, v254 dst_sel:WORD_0 dst_unused:UNUSED_PRESERVE src0_sel:WORD_0
    v_exp_f16_sdwa v255, v255 dst_sel:WORD_0 dst_unused:UNUSED_PRESERVE src0_sel:WORD_0
    v_exp_f16_sdwa v252, v252 dst_sel:WORD_1 dst_unused:UNUSED_PRESERVE src0_sel:WORD_1
    v_exp_f16_sdwa v253, v253 dst_sel:WORD_1 dst_unused:UNUSED_PRESERVE src0_sel:WORD_1
    v_exp_f16_sdwa v254, v254 dst_sel:WORD_1 dst_unused:UNUSED_PRESERVE src0_sel:WORD_1
    v_exp_f16_sdwa v255, v255 dst_sel:WORD_1 dst_unused:UNUSED_PRESERVE src0_sel:WORD_1
    v_pk_add_f16 v252, v252, s7
    v_pk_add_f16 v253, v253, s7
    v_pk_add_f16 v254, v254, s7
    v_pk_add_f16 v255, v255, s7
    v_rcp_f16_sdwa v252, v252 dst_sel:WORD_0 dst_unused:UNUSED_PRESERVE src0_sel:WORD_0
    v_rcp_f16_sdwa v253, v253 dst_sel:WORD_0 dst_unused:UNUSED_PRESERVE src0_sel:WORD_0
    v_rcp_f16_sdwa v254, v254 dst_sel:WORD_0 dst_unused:UNUSED_PRESERVE src0_sel:WORD_0
    v_rcp_f16_sdwa v255, v255 dst_sel:WORD_0 dst_unused:UNUSED_PRESERVE src0_sel:WORD_0
    v_rcp_f16_sdwa v252, v252 dst_sel:WORD_1 dst_unused:UNUSED_PRESERVE src0_sel:WORD_1
    v_rcp_f16_sdwa v253, v253 dst_sel:WORD_1 dst_unused:UNUSED_PRESERVE src0_sel:WORD_1
    v_rcp_f16_sdwa v254, v254 dst_sel:WORD_1 dst_unused:UNUSED_PRESERVE src0_sel:WORD_1
    v_rcp_f16_sdwa v255, v255 dst_sel:WORD_1 dst_unused:UNUSED_PRESERVE src0_sel:WORD_1
    v_fma_mix_f32 v196, v196, v252, 0 op_sel:[0,0,0] op_sel_hi:[0,1,0]
    v_fma_mix_f32 v197, v197, v252, 0 op_sel:[0,1,0] op_sel_hi:[0,1,0]
    v_fma_mix_f32 v198, v198, v253, 0 op_sel:[0,0,0] op_sel_hi:[0,1,0]
    v_fma_mix_f32 v199, v199, v253, 0 op_sel:[0,1,0] op_sel_hi:[0,1,0]
    v_fma_mix_f32 v200, v200, v254, 0 op_sel:[0,0,0] op_sel_hi:[0,1,0]
    v_fma_mix_f32 v201, v201, v254, 0 op_sel:[0,1,0] op_sel_hi:[0,1,0]
    v_fma_mix_f32 v202, v202, v255, 0 op_sel:[0,0,0] op_sel_hi:[0,1,0]
    v_fma_mix_f32 v203, v203, v255, 0 op_sel:[0,1,0] op_sel_hi:[0,1,0]
    v_cvt_pk_bf16_f32 v244, v196, v197
    v_cvt_pk_bf16_f32 v245, v198, v199
    v_cvt_pk_bf16_f32 v246, v200, v201
    v_cvt_pk_bf16_f32 v247, v202, v203
    v_cvt_pk_f16_f32 v252, v204, v205
    v_cvt_pk_f16_f32 v253, v206, v207
    v_cvt_pk_f16_f32 v254, v208, v209
    v_cvt_pk_f16_f32 v255, v210, v211
    v_pk_fma_f16 v248, v252, v252, s60
    v_pk_fma_f16 v249, v253, v253, s60
    v_pk_fma_f16 v250, v254, v254, s60
    v_pk_fma_f16 v251, v255, v255, s60
    v_pk_mul_f16 v252, v252, v248 neg_lo:[1,0] neg_hi:[1,0]
    v_pk_mul_f16 v253, v253, v249 neg_lo:[1,0] neg_hi:[1,0]
    v_pk_mul_f16 v254, v254, v250 neg_lo:[1,0] neg_hi:[1,0]
    v_pk_mul_f16 v255, v255, v251 neg_lo:[1,0] neg_hi:[1,0]
    v_exp_f16_sdwa v252, v252 dst_sel:WORD_0 dst_unused:UNUSED_PRESERVE src0_sel:WORD_0
    v_exp_f16_sdwa v253, v253 dst_sel:WORD_0 dst_unused:UNUSED_PRESERVE src0_sel:WORD_0
    v_exp_f16_sdwa v254, v254 dst_sel:WORD_0 dst_unused:UNUSED_PRESERVE src0_sel:WORD_0
    v_mfma_f32_32x32x16_bf16 v[212:227], v[148:151], v[100:103], v[228:243]
    ds_read_b64_tr_b16 v[148:149], v1 offset:0
    ds_read_b64_tr_b16 v[150:151], v1 offset:1024
    v_exp_f16_sdwa v255, v255 dst_sel:WORD_0 dst_unused:UNUSED_PRESERVE src0_sel:WORD_0
    v_mfma_f32_32x32x16_bf16 v[212:227], v[152:155], v[104:107], v[212:227]
    ds_read_b64_tr_b16 v[152:153], v1 offset:2048
    ds_read_b64_tr_b16 v[154:155], v1 offset:3072
    v_exp_f16_sdwa v252, v252 dst_sel:WORD_1 dst_unused:UNUSED_PRESERVE src0_sel:WORD_1
    v_exp_f16_sdwa v253, v253 dst_sel:WORD_1 dst_unused:UNUSED_PRESERVE src0_sel:WORD_1
    v_mfma_f32_32x32x16_bf16 v[212:227], v[156:159], v[108:111], v[212:227]
    ds_read_b64_tr_b16 v[156:157], v1 offset:4096
    ds_read_b64_tr_b16 v[158:159], v1 offset:5120
    v_exp_f16_sdwa v254, v254 dst_sel:WORD_1 dst_unused:UNUSED_PRESERVE src0_sel:WORD_1
    v_mfma_f32_32x32x16_bf16 v[212:227], v[160:163], v[112:115], v[212:227]
    s_cmp_eq_u32 s61, 0x10000
    ds_read_b64_tr_b16 v[160:161], v1 offset:6144
    ds_read_b64_tr_b16 v[162:163], v1 offset:7168
    v_exp_f16_sdwa v255, v255 dst_sel:WORD_1 dst_unused:UNUSED_PRESERVE src0_sel:WORD_1
    v_mfma_f32_32x32x16_bf16 v[212:227], v[164:167], v[116:119], v[212:227]
    ds_read_b64_tr_b16 v[164:165], v1 offset:8192
    ds_read_b64_tr_b16 v[166:167], v1 offset:9216
    v_pk_add_f16 v252, v252, s7
    v_pk_add_f16 v253, v253, s7
    v_pk_add_f16 v254, v254, s7
    v_pk_add_f16 v255, v255, s7
    v_mfma_f32_32x32x16_bf16 v[212:227], v[168:171], v[120:123], v[212:227]
    ds_read_b64_tr_b16 v[168:169], v1 offset:10240
    ds_read_b64_tr_b16 v[170:171], v1 offset:11264
    v_rcp_f16_sdwa v252, v252 dst_sel:WORD_0 dst_unused:UNUSED_PRESERVE src0_sel:WORD_0
    v_rcp_f16_sdwa v253, v253 dst_sel:WORD_0 dst_unused:UNUSED_PRESERVE src0_sel:WORD_0
    v_mfma_f32_32x32x16_bf16 v[212:227], v[172:175], v[124:127], v[212:227]
    ds_read_b64_tr_b16 v[172:173], v1 offset:12288
    ds_read_b64_tr_b16 v[174:175], v1 offset:13312
    v_rcp_f16_sdwa v254, v254 dst_sel:WORD_0 dst_unused:UNUSED_PRESERVE src0_sel:WORD_0
    v_mfma_f32_32x32x16_bf16 v[212:227], v[176:179], v[128:131], v[212:227]
    ds_read_b64_tr_b16 v[176:177], v1 offset:14336
    ds_read_b64_tr_b16 v[178:179], v1 offset:15360
    v_rcp_f16_sdwa v255, v255 dst_sel:WORD_0 dst_unused:UNUSED_PRESERVE src0_sel:WORD_0
    v_mfma_f32_32x32x16_bf16 v[212:227], v[180:183], v[132:135], v[212:227]
    ds_read_b64_tr_b16 v[180:181], v1 offset:16384
    ds_read_b64_tr_b16 v[182:183], v1 offset:17408
    v_rcp_f16_sdwa v252, v252 dst_sel:WORD_1 dst_unused:UNUSED_PRESERVE src0_sel:WORD_1
    v_rcp_f16_sdwa v253, v253 dst_sel:WORD_1 dst_unused:UNUSED_PRESERVE src0_sel:WORD_1
    v_mfma_f32_32x32x16_bf16 v[212:227], v[184:187], v[136:139], v[212:227]
    ds_read_b64_tr_b16 v[184:185], v1 offset:18432
    ds_read_b64_tr_b16 v[186:187], v1 offset:19456
    v_rcp_f16_sdwa v254, v254 dst_sel:WORD_1 dst_unused:UNUSED_PRESERVE src0_sel:WORD_1
    v_rcp_f16_sdwa v255, v255 dst_sel:WORD_1 dst_unused:UNUSED_PRESERVE src0_sel:WORD_1
    v_mfma_f32_32x32x16_bf16 v[212:227], v[188:191], v[140:143], v[212:227]
    ds_read_b64_tr_b16 v[188:189], v1 offset:20480
    ds_read_b64_tr_b16 v[190:191], v1 offset:21504
    v_fma_mix_f32 v204, v204, v252, 0 op_sel:[0,0,0] op_sel_hi:[0,1,0]
    v_fma_mix_f32 v205, v205, v252, 0 op_sel:[0,1,0] op_sel_hi:[0,1,0]
    v_mfma_f32_32x32x16_bf16 v[212:227], v[192:195], v[144:147], v[212:227]
    ds_read_b64_tr_b16 v[192:193], v1 offset:22528
    ds_read_b64_tr_b16 v[194:195], v1 offset:23552
    ds_write_b128 v3, v[244:247] offset:28672
    ds_read_b128 v[228:231], v2 offset:0
    ds_read_b128 v[232:235], v2 offset:32
    v_fma_mix_f32 v206, v206, v253, 0 op_sel:[0,0,0] op_sel_hi:[0,1,0]
    v_fma_mix_f32 v207, v207, v253, 0 op_sel:[0,1,0] op_sel_hi:[0,1,0]
    v_fma_mix_f32 v208, v208, v254, 0 op_sel:[0,0,0] op_sel_hi:[0,1,0]
    v_fma_mix_f32 v209, v209, v254, 0 op_sel:[0,1,0] op_sel_hi:[0,1,0]
    v_fma_mix_f32 v210, v210, v255, 0 op_sel:[0,0,0] op_sel_hi:[0,1,0]
    v_fma_mix_f32 v211, v211, v255, 0 op_sel:[0,1,0] op_sel_hi:[0,1,0]
    v_cvt_pk_bf16_f32 v248, v204, v205
    v_cvt_pk_bf16_f32 v249, v206, v207
    v_cvt_pk_bf16_f32 v250, v208, v209
    v_cvt_pk_bf16_f32 v251, v210, v211
    ds_write_b128 v3, v[248:251] offset:29696
    ds_read_b128 v[236:239], v2 offset:64
    ds_read_b128 v[240:243], v2 offset:96
    v_cvt_pk_f16_f32 v252, v212, v213
    v_cvt_pk_f16_f32 v253, v214, v215
    v_cvt_pk_f16_f32 v254, v216, v217
    v_cvt_pk_f16_f32 v255, v218, v219
    v_pk_fma_f16 v244, v252, v252, s60
    v_pk_fma_f16 v245, v253, v253, s60
    v_pk_fma_f16 v246, v254, v254, s60
    v_pk_fma_f16 v247, v255, v255, s60
    v_pk_mul_f16 v252, v252, v244 neg_lo:[1,0] neg_hi:[1,0]
    v_pk_mul_f16 v253, v253, v245 neg_lo:[1,0] neg_hi:[1,0]
    v_pk_mul_f16 v254, v254, v246 neg_lo:[1,0] neg_hi:[1,0]
    v_pk_mul_f16 v255, v255, v247 neg_lo:[1,0] neg_hi:[1,0]
    v_exp_f16_sdwa v252, v252 dst_sel:WORD_0 dst_unused:UNUSED_PRESERVE src0_sel:WORD_0
    v_exp_f16_sdwa v253, v253 dst_sel:WORD_0 dst_unused:UNUSED_PRESERVE src0_sel:WORD_0
    v_exp_f16_sdwa v254, v254 dst_sel:WORD_0 dst_unused:UNUSED_PRESERVE src0_sel:WORD_0
    v_exp_f16_sdwa v255, v255 dst_sel:WORD_0 dst_unused:UNUSED_PRESERVE src0_sel:WORD_0
    v_exp_f16_sdwa v252, v252 dst_sel:WORD_1 dst_unused:UNUSED_PRESERVE src0_sel:WORD_1
    v_exp_f16_sdwa v253, v253 dst_sel:WORD_1 dst_unused:UNUSED_PRESERVE src0_sel:WORD_1
    v_exp_f16_sdwa v254, v254 dst_sel:WORD_1 dst_unused:UNUSED_PRESERVE src0_sel:WORD_1
    v_exp_f16_sdwa v255, v255 dst_sel:WORD_1 dst_unused:UNUSED_PRESERVE src0_sel:WORD_1
    v_pk_add_f16 v252, v252, s7
    v_pk_add_f16 v253, v253, s7
    v_pk_add_f16 v254, v254, s7
    v_pk_add_f16 v255, v255, s7
    v_rcp_f16_sdwa v252, v252 dst_sel:WORD_0 dst_unused:UNUSED_PRESERVE src0_sel:WORD_0
    v_rcp_f16_sdwa v253, v253 dst_sel:WORD_0 dst_unused:UNUSED_PRESERVE src0_sel:WORD_0
    v_rcp_f16_sdwa v254, v254 dst_sel:WORD_0 dst_unused:UNUSED_PRESERVE src0_sel:WORD_0
    v_rcp_f16_sdwa v255, v255 dst_sel:WORD_0 dst_unused:UNUSED_PRESERVE src0_sel:WORD_0
    v_rcp_f16_sdwa v252, v252 dst_sel:WORD_1 dst_unused:UNUSED_PRESERVE src0_sel:WORD_1
    v_rcp_f16_sdwa v253, v253 dst_sel:WORD_1 dst_unused:UNUSED_PRESERVE src0_sel:WORD_1
    s_waitcnt lgkmcnt(0)
    s_cbranch_scc1 L_Ptail
    v_mfma_f32_32x32x16_bf16 v[196:211], v[148:151], v[4:7], v[228:243]
    v_rcp_f16_sdwa v254, v254 dst_sel:WORD_1 dst_unused:UNUSED_PRESERVE src0_sel:WORD_1
    v_rcp_f16_sdwa v255, v255 dst_sel:WORD_1 dst_unused:UNUSED_PRESERVE src0_sel:WORD_1
    v_fma_mix_f32 v212, v212, v252, 0 op_sel:[0,0,0] op_sel_hi:[0,1,0]
    v_fma_mix_f32 v213, v213, v252, 0 op_sel:[0,1,0] op_sel_hi:[0,1,0]
    v_mfma_f32_32x32x16_bf16 v[196:211], v[152:155], v[8:11], v[196:211]
    v_fma_mix_f32 v214, v214, v253, 0 op_sel:[0,0,0] op_sel_hi:[0,1,0]
    v_fma_mix_f32 v215, v215, v253, 0 op_sel:[0,1,0] op_sel_hi:[0,1,0]
    v_fma_mix_f32 v216, v216, v254, 0 op_sel:[0,0,0] op_sel_hi:[0,1,0]
    v_fma_mix_f32 v217, v217, v254, 0 op_sel:[0,1,0] op_sel_hi:[0,1,0]
    v_fma_mix_f32 v218, v218, v255, 0 op_sel:[0,0,0] op_sel_hi:[0,1,0]
    v_fma_mix_f32 v219, v219, v255, 0 op_sel:[0,1,0] op_sel_hi:[0,1,0]
    v_mfma_f32_32x32x16_bf16 v[196:211], v[156:159], v[12:15], v[196:211]
    v_cvt_pk_bf16_f32 v244, v212, v213
    v_cvt_pk_bf16_f32 v245, v214, v215
    v_cvt_pk_bf16_f32 v246, v216, v217
    v_cvt_pk_bf16_f32 v247, v218, v219
    v_cvt_pk_f16_f32 v252, v220, v221
    v_cvt_pk_f16_f32 v253, v222, v223
    v_mfma_f32_32x32x16_bf16 v[196:211], v[160:163], v[16:19], v[196:211]
    v_cvt_pk_f16_f32 v254, v224, v225
    v_cvt_pk_f16_f32 v255, v226, v227
    v_pk_fma_f16 v248, v252, v252, s60
    v_pk_fma_f16 v249, v253, v253, s60
    v_pk_fma_f16 v250, v254, v254, s60
    v_pk_fma_f16 v251, v255, v255, s60
    v_mfma_f32_32x32x16_bf16 v[196:211], v[164:167], v[20:23], v[196:211]
    v_pk_mul_f16 v252, v252, v248 neg_lo:[1,0] neg_hi:[1,0]
    v_pk_mul_f16 v253, v253, v249 neg_lo:[1,0] neg_hi:[1,0]
    v_pk_mul_f16 v254, v254, v250 neg_lo:[1,0] neg_hi:[1,0]
    v_pk_mul_f16 v255, v255, v251 neg_lo:[1,0] neg_hi:[1,0]
    v_exp_f16_sdwa v252, v252 dst_sel:WORD_0 dst_unused:UNUSED_PRESERVE src0_sel:WORD_0
    v_mfma_f32_32x32x16_bf16 v[196:211], v[168:171], v[24:27], v[196:211]
    v_exp_f16_sdwa v253, v253 dst_sel:WORD_0 dst_unused:UNUSED_PRESERVE src0_sel:WORD_0
    v_exp_f16_sdwa v254, v254 dst_sel:WORD_0 dst_unused:UNUSED_PRESERVE src0_sel:WORD_0
    v_exp_f16_sdwa v255, v255 dst_sel:WORD_0 dst_unused:UNUSED_PRESERVE src0_sel:WORD_0
    v_mfma_f32_32x32x16_bf16 v[196:211], v[172:175], v[28:31], v[196:211]
    v_exp_f16_sdwa v252, v252 dst_sel:WORD_1 dst_unused:UNUSED_PRESERVE src0_sel:WORD_1
    v_exp_f16_sdwa v253, v253 dst_sel:WORD_1 dst_unused:UNUSED_PRESERVE src0_sel:WORD_1
    v_exp_f16_sdwa v254, v254 dst_sel:WORD_1 dst_unused:UNUSED_PRESERVE src0_sel:WORD_1
    v_mfma_f32_32x32x16_bf16 v[196:211], v[176:179], v[32:35], v[196:211]
    v_exp_f16_sdwa v255, v255 dst_sel:WORD_1 dst_unused:UNUSED_PRESERVE src0_sel:WORD_1
    v_pk_add_f16 v252, v252, s7
    v_pk_add_f16 v253, v253, s7
    v_pk_add_f16 v254, v254, s7
    v_pk_add_f16 v255, v255, s7
    v_mfma_f32_32x32x16_bf16 v[196:211], v[180:183], v[36:39], v[196:211]
    v_rcp_f16_sdwa v252, v252 dst_sel:WORD_0 dst_unused:UNUSED_PRESERVE src0_sel:WORD_0
    v_rcp_f16_sdwa v253, v253 dst_sel:WORD_0 dst_unused:UNUSED_PRESERVE src0_sel:WORD_0
    v_rcp_f16_sdwa v254, v254 dst_sel:WORD_0 dst_unused:UNUSED_PRESERVE src0_sel:WORD_0
    v_mfma_f32_32x32x16_bf16 v[196:211], v[184:187], v[40:43], v[196:211]
    v_rcp_f16_sdwa v255, v255 dst_sel:WORD_0 dst_unused:UNUSED_PRESERVE src0_sel:WORD_0
    v_rcp_f16_sdwa v252, v252 dst_sel:WORD_1 dst_unused:UNUSED_PRESERVE src0_sel:WORD_1
    v_rcp_f16_sdwa v253, v253 dst_sel:WORD_1 dst_unused:UNUSED_PRESERVE src0_sel:WORD_1
    v_mfma_f32_32x32x16_bf16 v[196:211], v[188:191], v[44:47], v[196:211]
    v_rcp_f16_sdwa v254, v254 dst_sel:WORD_1 dst_unused:UNUSED_PRESERVE src0_sel:WORD_1
    v_rcp_f16_sdwa v255, v255 dst_sel:WORD_1 dst_unused:UNUSED_PRESERVE src0_sel:WORD_1
    v_fma_mix_f32 v220, v220, v252, 0 op_sel:[0,0,0] op_sel_hi:[0,1,0]
    v_fma_mix_f32 v221, v221, v252, 0 op_sel:[0,1,0] op_sel_hi:[0,1,0]
    v_mfma_f32_32x32x16_bf16 v[196:211], v[192:195], v[48:51], v[196:211]
    ds_write_b128 v3, v[244:247] offset:32768
    v_fma_mix_f32 v222, v222, v253, 0 op_sel:[0,0,0] op_sel_hi:[0,1,0]
    v_fma_mix_f32 v223, v223, v253, 0 op_sel:[0,1,0] op_sel_hi:[0,1,0]
    v_fma_mix_f32 v224, v224, v254, 0 op_sel:[0,0,0] op_sel_hi:[0,1,0]
    v_fma_mix_f32 v225, v225, v254, 0 op_sel:[0,1,0] op_sel_hi:[0,1,0]
    v_fma_mix_f32 v226, v226, v255, 0 op_sel:[0,0,0] op_sel_hi:[0,1,0]
    v_fma_mix_f32 v227, v227, v255, 0 op_sel:[0,1,0] op_sel_hi:[0,1,0]
    v_cvt_pk_bf16_f32 v248, v220, v221
    v_cvt_pk_bf16_f32 v249, v222, v223
    v_cvt_pk_bf16_f32 v250, v224, v225
    v_cvt_pk_bf16_f32 v251, v226, v227
    ds_write_b128 v3, v[248:251] offset:33792
    v_cvt_pk_f16_f32 v252, v196, v197
    v_cvt_pk_f16_f32 v253, v198, v199
    v_cvt_pk_f16_f32 v254, v200, v201
    v_cvt_pk_f16_f32 v255, v202, v203
    v_pk_fma_f16 v244, v252, v252, s60
    v_pk_fma_f16 v245, v253, v253, s60
    v_pk_fma_f16 v246, v254, v254, s60
    v_pk_fma_f16 v247, v255, v255, s60
    v_pk_mul_f16 v252, v252, v244 neg_lo:[1,0] neg_hi:[1,0]
    v_pk_mul_f16 v253, v253, v245 neg_lo:[1,0] neg_hi:[1,0]
    v_pk_mul_f16 v254, v254, v246 neg_lo:[1,0] neg_hi:[1,0]
    v_pk_mul_f16 v255, v255, v247 neg_lo:[1,0] neg_hi:[1,0]
    v_exp_f16_sdwa v252, v252 dst_sel:WORD_0 dst_unused:UNUSED_PRESERVE src0_sel:WORD_0
    v_exp_f16_sdwa v253, v253 dst_sel:WORD_0 dst_unused:UNUSED_PRESERVE src0_sel:WORD_0
    v_exp_f16_sdwa v254, v254 dst_sel:WORD_0 dst_unused:UNUSED_PRESERVE src0_sel:WORD_0
    v_exp_f16_sdwa v255, v255 dst_sel:WORD_0 dst_unused:UNUSED_PRESERVE src0_sel:WORD_0
    v_exp_f16_sdwa v252, v252 dst_sel:WORD_1 dst_unused:UNUSED_PRESERVE src0_sel:WORD_1
    v_exp_f16_sdwa v253, v253 dst_sel:WORD_1 dst_unused:UNUSED_PRESERVE src0_sel:WORD_1
    v_exp_f16_sdwa v254, v254 dst_sel:WORD_1 dst_unused:UNUSED_PRESERVE src0_sel:WORD_1
    v_exp_f16_sdwa v255, v255 dst_sel:WORD_1 dst_unused:UNUSED_PRESERVE src0_sel:WORD_1
    v_pk_add_f16 v252, v252, s7
    v_pk_add_f16 v253, v253, s7
    v_pk_add_f16 v254, v254, s7
    v_pk_add_f16 v255, v255, s7
    v_rcp_f16_sdwa v252, v252 dst_sel:WORD_0 dst_unused:UNUSED_PRESERVE src0_sel:WORD_0
    v_rcp_f16_sdwa v253, v253 dst_sel:WORD_0 dst_unused:UNUSED_PRESERVE src0_sel:WORD_0
    v_rcp_f16_sdwa v254, v254 dst_sel:WORD_0 dst_unused:UNUSED_PRESERVE src0_sel:WORD_0
    v_rcp_f16_sdwa v255, v255 dst_sel:WORD_0 dst_unused:UNUSED_PRESERVE src0_sel:WORD_0
    v_rcp_f16_sdwa v252, v252 dst_sel:WORD_1 dst_unused:UNUSED_PRESERVE src0_sel:WORD_1
    v_rcp_f16_sdwa v253, v253 dst_sel:WORD_1 dst_unused:UNUSED_PRESERVE src0_sel:WORD_1
    v_rcp_f16_sdwa v254, v254 dst_sel:WORD_1 dst_unused:UNUSED_PRESERVE src0_sel:WORD_1
    v_rcp_f16_sdwa v255, v255 dst_sel:WORD_1 dst_unused:UNUSED_PRESERVE src0_sel:WORD_1
    v_fma_mix_f32 v196, v196, v252, 0 op_sel:[0,0,0] op_sel_hi:[0,1,0]
    v_fma_mix_f32 v197, v197, v252, 0 op_sel:[0,1,0] op_sel_hi:[0,1,0]
    v_fma_mix_f32 v198, v198, v253, 0 op_sel:[0,0,0] op_sel_hi:[0,1,0]
    v_fma_mix_f32 v199, v199, v253, 0 op_sel:[0,1,0] op_sel_hi:[0,1,0]
    v_fma_mix_f32 v200, v200, v254, 0 op_sel:[0,0,0] op_sel_hi:[0,1,0]
    v_fma_mix_f32 v201, v201, v254, 0 op_sel:[0,1,0] op_sel_hi:[0,1,0]
    v_mfma_f32_32x32x16_bf16 v[212:227], v[148:151], v[52:55], v[228:243]
    s_branch L_Ploop
L_Ptail:
    s_waitcnt lgkmcnt(0)
    s_add_u32 s62, s4, s34
    s_mul_i32 s62, s62, 86016
    s_mul_i32 s63, s5, 384
    s_add_u32 s62, s62, s63
    s_mul_i32 s64, s34, 6144
    v_lshlrev_b32 v12, 4, v0
    v_add_u32 v13, s64, v12
    v_add_u32 v12, 160000, v12
    s_add_u32 s65, s62, 688128
    v_rcp_f16_sdwa v254, v254 dst_sel:WORD_1 dst_unused:UNUSED_PRESERVE src0_sel:WORD_1
    v_rcp_f16_sdwa v255, v255 dst_sel:WORD_1 dst_unused:UNUSED_PRESERVE src0_sel:WORD_1
    v_fma_mix_f32 v212, v212, v252, 0 op_sel:[0,0,0] op_sel_hi:[0,1,0]
    v_fma_mix_f32 v213, v213, v252, 0 op_sel:[0,1,0] op_sel_hi:[0,1,0]
    v_fma_mix_f32 v214, v214, v253, 0 op_sel:[0,0,0] op_sel_hi:[0,1,0]
    v_fma_mix_f32 v215, v215, v253, 0 op_sel:[0,1,0] op_sel_hi:[0,1,0]
    v_fma_mix_f32 v216, v216, v254, 0 op_sel:[0,0,0] op_sel_hi:[0,1,0]
    v_fma_mix_f32 v217, v217, v254, 0 op_sel:[0,1,0] op_sel_hi:[0,1,0]
    v_fma_mix_f32 v218, v218, v255, 0 op_sel:[0,0,0] op_sel_hi:[0,1,0]
    v_fma_mix_f32 v219, v219, v255, 0 op_sel:[0,1,0] op_sel_hi:[0,1,0]
    v_cvt_pk_bf16_f32 v244, v212, v213
    v_cvt_pk_bf16_f32 v245, v214, v215
    v_cvt_pk_bf16_f32 v246, v216, v217
    v_cvt_pk_bf16_f32 v247, v218, v219
    v_cvt_pk_f16_f32 v252, v220, v221
    v_cvt_pk_f16_f32 v253, v222, v223
    v_cvt_pk_f16_f32 v254, v224, v225
    v_cvt_pk_f16_f32 v255, v226, v227
    v_pk_fma_f16 v248, v252, v252, s60
    v_pk_fma_f16 v249, v253, v253, s60
    v_pk_fma_f16 v250, v254, v254, s60
    v_pk_fma_f16 v251, v255, v255, s60
    v_pk_mul_f16 v252, v252, v248 neg_lo:[1,0] neg_hi:[1,0]
    v_pk_mul_f16 v253, v253, v249 neg_lo:[1,0] neg_hi:[1,0]
    v_pk_mul_f16 v254, v254, v250 neg_lo:[1,0] neg_hi:[1,0]
    v_pk_mul_f16 v255, v255, v251 neg_lo:[1,0] neg_hi:[1,0]
    v_exp_f16_sdwa v252, v252 dst_sel:WORD_0 dst_unused:UNUSED_PRESERVE src0_sel:WORD_0
    v_exp_f16_sdwa v253, v253 dst_sel:WORD_0 dst_unused:UNUSED_PRESERVE src0_sel:WORD_0
    v_exp_f16_sdwa v254, v254 dst_sel:WORD_0 dst_unused:UNUSED_PRESERVE src0_sel:WORD_0
    v_exp_f16_sdwa v255, v255 dst_sel:WORD_0 dst_unused:UNUSED_PRESERVE src0_sel:WORD_0
    v_exp_f16_sdwa v252, v252 dst_sel:WORD_1 dst_unused:UNUSED_PRESERVE src0_sel:WORD_1
    v_exp_f16_sdwa v253, v253 dst_sel:WORD_1 dst_unused:UNUSED_PRESERVE src0_sel:WORD_1
    v_exp_f16_sdwa v254, v254 dst_sel:WORD_1 dst_unused:UNUSED_PRESERVE src0_sel:WORD_1
    v_exp_f16_sdwa v255, v255 dst_sel:WORD_1 dst_unused:UNUSED_PRESERVE src0_sel:WORD_1
    v_pk_add_f16 v252, v252, s7
    v_pk_add_f16 v253, v253, s7
    v_pk_add_f16 v254, v254, s7
    v_pk_add_f16 v255, v255, s7
    v_rcp_f16_sdwa v252, v252 dst_sel:WORD_0 dst_unused:UNUSED_PRESERVE src0_sel:WORD_0
    v_rcp_f16_sdwa v253, v253 dst_sel:WORD_0 dst_unused:UNUSED_PRESERVE src0_sel:WORD_0
    v_rcp_f16_sdwa v254, v254 dst_sel:WORD_0 dst_unused:UNUSED_PRESERVE src0_sel:WORD_0
    v_rcp_f16_sdwa v255, v255 dst_sel:WORD_0 dst_unused:UNUSED_PRESERVE src0_sel:WORD_0
    v_rcp_f16_sdwa v252, v252 dst_sel:WORD_1 dst_unused:UNUSED_PRESERVE src0_sel:WORD_1
    v_rcp_f16_sdwa v253, v253 dst_sel:WORD_1 dst_unused:UNUSED_PRESERVE src0_sel:WORD_1
    v_rcp_f16_sdwa v254, v254 dst_sel:WORD_1 dst_unused:UNUSED_PRESERVE src0_sel:WORD_1
    v_rcp_f16_sdwa v255, v255 dst_sel:WORD_1 dst_unused:UNUSED_PRESERVE src0_sel:WORD_1
    v_fma_mix_f32 v220, v220, v252, 0 op_sel:[0,0,0] op_sel_hi:[0,1,0]
    v_fma_mix_f32 v221, v221, v252, 0 op_sel:[0,1,0] op_sel_hi:[0,1,0]
    ds_write_b128 v3, v[244:247] offset:32768
    v_fma_mix_f32 v222, v222, v253, 0 op_sel:[0,0,0] op_sel_hi:[0,1,0]
    v_fma_mix_f32 v223, v223, v253, 0 op_sel:[0,1,0] op_sel_hi:[0,1,0]
    v_fma_mix_f32 v224, v224, v254, 0 op_sel:[0,0,0] op_sel_hi:[0,1,0]
    v_fma_mix_f32 v225, v225, v254, 0 op_sel:[0,1,0] op_sel_hi:[0,1,0]
    v_fma_mix_f32 v226, v226, v255, 0 op_sel:[0,0,0] op_sel_hi:[0,1,0]
    v_fma_mix_f32 v227, v227, v255, 0 op_sel:[0,1,0] op_sel_hi:[0,1,0]
    v_cvt_pk_bf16_f32 v248, v220, v221
    v_cvt_pk_bf16_f32 v249, v222, v223
    v_cvt_pk_bf16_f32 v250, v224, v225
    v_cvt_pk_bf16_f32 v251, v226, v227
    ds_write_b128 v3, v[248:251] offset:33792
    ds_read_b128 v[4:7], v12 offset:0
    ds_read_b128 v[8:11], v12 offset:1024
    s_waitcnt lgkmcnt(0)
    s_barrier
    s_add_u32 m0, s64, 49152
    s_nop 0
    buffer_load_dwordx4 v4, s[8:11], s65 offen lds
    s_add_u32 m0, s64, 50176
    s_nop 0
    buffer_load_dwordx4 v5, s[8:11], s65 offen lds
    s_add_u32 m0, s64, 51200
    s_nop 0
    buffer_load_dwordx4 v6, s[8:11], s65 offen lds
    s_add_u32 m0, s64, 52224
    s_nop 0
    buffer_load_dwordx4 v7, s[8:11], s65 offen lds
    s_add_u32 m0, s64, 53248
    s_nop 0
    buffer_load_dwordx4 v8, s[8:11], s65 offen lds
    s_add_u32 m0, s64, 54272
    s_nop 0
    buffer_load_dwordx4 v9, s[8:11], s65 offen lds
    s_barrier
    s_waitcnt vmcnt(0)
    s_barrier
    ds_read_b128 v[16:19], v13 offset:0
    s_waitcnt lgkmcnt(0)
    buffer_store_dwordx4 v[16:19], v4, s[12:15], s62 offen nt
    ds_read_b128 v[20:23], v13 offset:1024
    s_waitcnt lgkmcnt(0)
    buffer_store_dwordx4 v[20:23], v5, s[12:15], s62 offen nt
    ds_read_b128 v[24:27], v13 offset:2048
    s_waitcnt lgkmcnt(0)
    buffer_store_dwordx4 v[24:27], v6, s[12:15], s62 offen nt
    ds_read_b128 v[28:31], v13 offset:3072
    s_waitcnt lgkmcnt(0)
    buffer_store_dwordx4 v[28:31], v7, s[12:15], s62 offen nt
    ds_read_b128 v[32:35], v13 offset:4096
    s_waitcnt lgkmcnt(0)
    buffer_store_dwordx4 v[32:35], v8, s[12:15], s62 offen nt
    ds_read_b128 v[36:39], v13 offset:5120
    s_waitcnt lgkmcnt(0)
    buffer_store_dwordx4 v[36:39], v9, s[12:15], s62 offen nt
    s_add_u32 s62, s62, 344064
    s_barrier
    ds_read_b128 v[40:43], v13 offset:24576
    s_waitcnt lgkmcnt(0)
    buffer_store_dwordx4 v[40:43], v4, s[12:15], s62 offen nt
    ds_read_b128 v[44:47], v13 offset:25600
    s_waitcnt lgkmcnt(0)
    buffer_store_dwordx4 v[44:47], v5, s[12:15], s62 offen nt
    ds_read_b128 v[48:51], v13 offset:26624
    s_waitcnt lgkmcnt(0)
    buffer_store_dwordx4 v[48:51], v6, s[12:15], s62 offen nt
    ds_read_b128 v[52:55], v13 offset:27648
    s_waitcnt lgkmcnt(0)
    buffer_store_dwordx4 v[52:55], v7, s[12:15], s62 offen nt
    ds_read_b128 v[56:59], v13 offset:28672
    s_waitcnt lgkmcnt(0)
    buffer_store_dwordx4 v[56:59], v8, s[12:15], s62 offen nt
    ds_read_b128 v[60:63], v13 offset:29696
    s_waitcnt lgkmcnt(0)
    buffer_store_dwordx4 v[60:63], v9, s[12:15], s62 offen nt
    s_add_u32 s62, s62, 344064
    s_barrier
    ds_read_b128 v[64:67], v13 offset:49152
    ds_read_b128 v[68:71], v13 offset:50176
    ds_read_b128 v[72:75], v13 offset:51200
    ds_read_b128 v[76:79], v13 offset:52224
    ds_read_b128 v[80:83], v13 offset:53248
    ds_read_b128 v[84:87], v13 offset:54272
    s_waitcnt lgkmcnt(5)
    buffer_store_dwordx4 v[64:67], v4, s[12:15], s62 offen nt
    s_waitcnt lgkmcnt(4)
    buffer_store_dwordx4 v[68:71], v5, s[12:15], s62 offen nt
    s_waitcnt lgkmcnt(3)
    buffer_store_dwordx4 v[72:75], v6, s[12:15], s62 offen nt
    s_waitcnt lgkmcnt(2)
    buffer_store_dwordx4 v[76:79], v7, s[12:15], s62 offen nt
    s_waitcnt lgkmcnt(1)
    buffer_store_dwordx4 v[80:83], v8, s[12:15], s62 offen nt
    s_waitcnt lgkmcnt(0)
    buffer_store_dwordx4 v[84:87], v9, s[12:15], s62 offen nt
    s_add_u32 s62, s62, 344064
    s_endpgm
L_Q:
    s_waitcnt lgkmcnt(0)
    s_barrier
    ds_read_b64 v[196:197], v121 offset:0
    ds_read_b64 v[198:199], v121 offset:256
    ds_read_b64 v[200:201], v121 offset:512
    ds_read_b64 v[202:203], v121 offset:768
    ds_read_b64 v[204:205], v121 offset:1024
    ds_read_b64 v[206:207], v121 offset:1280
    ds_read_b64 v[208:209], v121 offset:1536
    s_waitcnt lgkmcnt(6)
    s_nop 0
    v_pk_fma_f32 v[44:45], v[44:45], v[196:197], v[196:197] op_sel:[0,1,0] op_sel_hi:[1,1,0] neg_lo:[0,0,1] neg_hi:[0,0,1]
    v_pk_fma_f32 v[46:47], v[46:47], v[196:197], v[196:197] op_sel:[0,1,0] op_sel_hi:[1,1,0] neg_lo:[0,0,1] neg_hi:[0,0,1]
    v_pk_fma_f32 v[48:49], v[48:49], v[196:197], v[196:197] op_sel:[0,1,0] op_sel_hi:[1,1,0] neg_lo:[0,0,1] neg_hi:[0,0,1]
    v_pk_fma_f32 v[50:51], v[50:51], v[196:197], v[196:197] op_sel:[0,1,0] op_sel_hi:[1,1,0] neg_lo:[0,0,1] neg_hi:[0,0,1]
    v_pk_fma_f32 v[52:53], v[52:53], v[196:197], v[196:197] op_sel:[0,1,0] op_sel_hi:[1,1,0] neg_lo:[0,0,1] neg_hi:[0,0,1]
    v_pk_fma_f32 v[54:55], v[54:55], v[196:197], v[196:197] op_sel:[0,1,0] op_sel_hi:[1,1,0] neg_lo:[0,0,1] neg_hi:[0,0,1]
    v_cvt_pk_bf16_f32 v44, v44, v45
    v_cvt_pk_bf16_f32 v45, v46, v47
    v_cvt_pk_bf16_f32 v46, v48, v49
    v_cvt_pk_bf16_f32 v47, v50, v51
    v_cvt_pk_bf16_f32 v48, v52, v53
    v_cvt_pk_bf16_f32 v49, v54, v55
    s_waitcnt lgkmcnt(5)
    s_nop 0
    v_pk_fma_f32 v[56:57], v[56:57], v[198:199], v[198:199] op_sel:[0,1,0] op_sel_hi:[1,1,0] neg_lo:[0,0,1] neg_hi:[0,0,1]
    v_pk_fma_f32 v[58:59], v[58:59], v[198:199], v[198:199] op_sel:[0,1,0] op_sel_hi:[1,1,0] neg_lo:[0,0,1] neg_hi:[0,0,1]
    v_pk_fma_f32 v[60:61], v[60:61], v[198:199], v[198:199] op_sel:[0,1,0] op_sel_hi:[1,1,0] neg_lo:[0,0,1] neg_hi:[0,0,1]
    v_pk_fma_f32 v[62:63], v[62:63], v[198:199], v[198:199] op_sel:[0,1,0] op_sel_hi:[1,1,0] neg_lo:[0,0,1] neg_hi:[0,0,1]
    ds_write_b64 v109, v[44:45] offset:0
    v_pk_fma_f32 v[64:65], v[64:65], v[198:199], v[198:199] op_sel:[0,1,0] op_sel_hi:[1,1,0] neg_lo:[0,0,1] neg_hi:[0,0,1]
    v_pk_fma_f32 v[66:67], v[66:67], v[198:199], v[198:199] op_sel:[0,1,0] op_sel_hi:[1,1,0] neg_lo:[0,0,1] neg_hi:[0,0,1]
    v_cvt_pk_bf16_f32 v56, v56, v57
    v_cvt_pk_bf16_f32 v57, v58, v59
    ds_write_b64 v109, v[46:47] offset:512
    v_cvt_pk_bf16_f32 v58, v60, v61
    v_cvt_pk_bf16_f32 v59, v62, v63
    v_cvt_pk_bf16_f32 v60, v64, v65
    v_cvt_pk_bf16_f32 v61, v66, v67
    ds_write_b64 v109, v[48:49] offset:1024
    s_waitcnt lgkmcnt(7)
    s_nop 0
    v_pk_fma_f32 v[68:69], v[68:69], v[200:201], v[200:201] op_sel:[0,1,0] op_sel_hi:[1,1,0] neg_lo:[0,0,1] neg_hi:[0,0,1]
    v_pk_fma_f32 v[70:71], v[70:71], v[200:201], v[200:201] op_sel:[0,1,0] op_sel_hi:[1,1,0] neg_lo:[0,0,1] neg_hi:[0,0,1]
    v_pk_fma_f32 v[72:73], v[72:73], v[200:201], v[200:201] op_sel:[0,1,0] op_sel_hi:[1,1,0] neg_lo:[0,0,1] neg_hi:[0,0,1]
    v_pk_fma_f32 v[74:75], v[74:75], v[200:201], v[200:201] op_sel:[0,1,0] op_sel_hi:[1,1,0] neg_lo:[0,0,1] neg_hi:[0,0,1]
    ds_write_b64 v109, v[56:57] offset:13824
    v_pk_fma_f32 v[76:77], v[76:77], v[200:201], v[200:201] op_sel:[0,1,0] op_sel_hi:[1,1,0] neg_lo:[0,0,1] neg_hi:[0,0,1]
    v_pk_fma_f32 v[78:79], v[78:79], v[200:201], v[200:201] op_sel:[0,1,0] op_sel_hi:[1,1,0] neg_lo:[0,0,1] neg_hi:[0,0,1]
    v_cvt_pk_bf16_f32 v68, v68, v69
    v_cvt_pk_bf16_f32 v69, v70, v71
    ds_write_b64 v109, v[58:59] offset:14336
    v_cvt_pk_bf16_f32 v70, v72, v73
    v_cvt_pk_bf16_f32 v71, v74, v75
    v_cvt_pk_bf16_f32 v72, v76, v77
    v_cvt_pk_bf16_f32 v73, v78, v79
    ds_write_b64 v109, v[60:61] offset:14848
    s_waitcnt lgkmcnt(9)
    s_nop 0
    v_pk_fma_f32 v[80:81], v[80:81], v[202:203], v[202:203] op_sel:[0,1,0] op_sel_hi:[1,1,0] neg_lo:[0,0,1] neg_hi:[0,0,1]
    v_pk_fma_f32 v[82:83], v[82:83], v[202:203], v[202:203] op_sel:[0,1,0] op_sel_hi:[1,1,0] neg_lo:[0,0,1] neg_hi:[0,0,1]
    v_pk_fma_f32 v[84:85], v[84:85], v[202:203], v[202:203] op_sel:[0,1,0] op_sel_hi:[1,1,0] neg_lo:[0,0,1] neg_hi:[0,0,1]
    v_pk_fma_f32 v[86:87], v[86:87], v[202:203], v[202:203] op_sel:[0,1,0] op_sel_hi:[1,1,0] neg_lo:[0,0,1] neg_hi:[0,0,1]
    ds_write_b64 v109, v[68:69] offset:27648
    v_pk_fma_f32 v[88:89], v[88:89], v[202:203], v[202:203] op_sel:[0,1,0] op_sel_hi:[1,1,0] neg_lo:[0,0,1] neg_hi:[0,0,1]
    v_pk_fma_f32 v[90:91], v[90:91], v[202:203], v[202:203] op_sel:[0,1,0] op_sel_hi:[1,1,0] neg_lo:[0,0,1] neg_hi:[0,0,1]
    v_cvt_pk_bf16_f32 v80, v80, v81
    v_cvt_pk_bf16_f32 v81, v82, v83
    ds_write_b64 v109, v[70:71] offset:28160
    v_cvt_pk_bf16_f32 v82, v84, v85
    v_cvt_pk_bf16_f32 v83, v86, v87
    v_cvt_pk_bf16_f32 v84, v88, v89
    v_cvt_pk_bf16_f32 v85, v90, v91
    ds_write_b64 v109, v[72:73] offset:28672
    ds_write_b64 v109, v[80:81] offset:41472
    ds_write_b64 v109, v[82:83] offset:41984
    ds_write_b64 v109, v[84:85] offset:42496
    s_waitcnt lgkmcnt(0)
    s_barrier
    v_fma_f32 v124, v124, v205, -v204
    v_fma_f32 v125, v125, v205, -v204
    v_fma_f32 v126, v126, v205, -v204
    v_fma_f32 v127, v127, v205, -v204
    v_fma_f32 v128, v128, v205, -v204
    v_fma_f32 v129, v129, v205, -v204
    v_fma_f32 v130, v130, v205, -v204
    v_fma_f32 v131, v131, v205, -v204
    v_fma_f32 v132, v132, v205, -v204
    v_fma_f32 v133, v133, v205, -v204
    v_fma_f32 v134, v134, v205, -v204
    v_fma_f32 v135, v135, v205, -v204
    v_cvt_pk_bf16_f32 v124, v124, v125
    v_cvt_pk_bf16_f32 v125, v126, v127
    v_cvt_pk_bf16_f32 v126, v128, v129
    v_cvt_pk_bf16_f32 v127, v130, v131
    v_cvt_pk_bf16_f32 v128, v132, v133
    v_cvt_pk_bf16_f32 v129, v134, v135
    v_fma_f32 v136, v136, v207, -v206
    v_fma_f32 v137, v137, v207, -v206
    v_fma_f32 v138, v138, v207, -v206
    v_fma_f32 v139, v139, v207, -v206
    v_fma_f32 v140, v140, v207, -v206
    v_fma_f32 v141, v141, v207, -v206
    ds_write_b64 v110, v[124:125] offset:0
    v_fma_f32 v142, v142, v207, -v206
    v_fma_f32 v143, v143, v207, -v206
    v_fma_f32 v144, v144, v207, -v206
    v_fma_f32 v145, v145, v207, -v206
    v_fma_f32 v146, v146, v207, -v206
    v_fma_f32 v147, v147, v207, -v206
    ds_write_b64 v110, v[126:127] offset:512
    v_cvt_pk_bf16_f32 v136, v136, v137
    v_cvt_pk_bf16_f32 v137, v138, v139
    v_cvt_pk_bf16_f32 v138, v140, v141
    v_cvt_pk_bf16_f32 v139, v142, v143
    v_cvt_pk_bf16_f32 v140, v144, v145
    v_cvt_pk_bf16_f32 v141, v146, v147
    ds_write_b64 v110, v[128:129] offset:1024
    v_fma_f32 v236, v236, v209, -v208
    v_fma_f32 v237, v237, v209, -v208
    v_fma_f32 v238, v238, v209, -v208
    v_fma_f32 v239, v239, v209, -v208
    v_fma_f32 v240, v240, v209, -v208
    v_fma_f32 v241, v241, v209, -v208
    ds_write_b64 v110, v[136:137] offset:13824
    v_fma_f32 v242, v242, v209, -v208
    v_fma_f32 v243, v243, v209, -v208
    v_fma_f32 v244, v244, v209, -v208
    v_fma_f32 v245, v245, v209, -v208
    v_fma_f32 v246, v246, v209, -v208
    v_fma_f32 v247, v247, v209, -v208
    ds_write_b64 v110, v[138:139] offset:14336
    v_cvt_pk_bf16_f32 v236, v236, v237
    v_cvt_pk_bf16_f32 v237, v238, v239
    v_cvt_pk_bf16_f32 v238, v240, v241
    v_cvt_pk_bf16_f32 v239, v242, v243
    v_cvt_pk_bf16_f32 v240, v244, v245
    v_cvt_pk_bf16_f32 v241, v246, v247
    ds_write_b64 v110, v[140:141] offset:14848
    ds_write_b64 v110, v[236:237] offset:27648
    ds_write_b64 v110, v[238:239] offset:28160
    ds_write_b64 v110, v[240:241] offset:28672
    s_waitcnt lgkmcnt(0)
    s_barrier
    ds_read_b64 v[160:161], v252 offset:0
    ds_read_b64 v[162:163], v252 offset:512
    ds_read_b64 v[164:165], v252 offset:2048
    ds_read_b64 v[166:167], v252 offset:2560
    ds_read_b64 v[168:169], v252 offset:4096
    ds_read_b64 v[170:171], v252 offset:4608
    ds_read_b64 v[172:173], v252 offset:6144
    ds_read_b64 v[174:175], v252 offset:6656
    ds_read_b64 v[176:177], v252 offset:8192
    ds_read_b64 v[178:179], v252 offset:8704
    ds_read_b64 v[180:181], v252 offset:10240
    ds_read_b64 v[182:183], v252 offset:10752
    ds_read_b128 v[196:199], v4 offset:0
    ds_read_b64_tr_b16 v[208:209], v3 offset:0
    ds_read_b64_tr_b16 v[210:211], v3 offset:1024
    ds_read_b64_tr_b16 v[212:213], v3 offset:4096
    ds_read_b64_tr_b16 v[214:215], v3 offset:5120
    ds_read_b64_tr_b16 v[216:217], v3 offset:8192
    ds_read_b64_tr_b16 v[218:219], v3 offset:9216
    ds_read_b64_tr_b16 v[220:221], v3 offset:12288
    ds_read_b64_tr_b16 v[222:223], v3 offset:13312
    ds_read_b64_tr_b16 v[224:225], v3 offset:16384
    ds_read_b64_tr_b16 v[226:227], v3 offset:17408
    ds_read_b64_tr_b16 v[228:229], v3 offset:20480
    ds_read_b64_tr_b16 v[230:231], v3 offset:21504
    s_waitcnt lgkmcnt(0)
    s_barrier
    v_mov_b32 v206, v42
    v_mov_b32 v207, v43
    s_add_u32 m0, s52, 0
    s_nop 0
    buffer_load_dwordx4 v10, s[16:19], s40 offen lds
    ds_read_b128 v[16:19], v253 offset:0
    ds_read_b128 v[20:23], v253 offset:16
    ds_read_b128 v[24:27], v253 offset:64
    ds_read_b128 v[28:31], v253 offset:80
    s_waitcnt lgkmcnt(0)
    s_add_u32 m0, s52, 49152
    s_nop 0
    buffer_load_dwordx4 v11, s[20:23], s46 offen lds
    ds_read_b128 v[32:35], v253 offset:128
    ds_read_b128 v[36:39], v253 offset:144
    ds_read_b128 v[40:43], v253 offset:192
    ds_read_b128 v[44:47], v253 offset:208
    s_waitcnt lgkmcnt(0)
    v_mfma_f32_16x16x32_bf16 v[196:199], v[208:211], v[160:163], v[196:199]
    v_mfma_f32_16x16x32_bf16 v[196:199], v[212:215], v[164:167], v[196:199]
    v_mfma_f32_16x16x32_bf16 v[196:199], v[216:219], v[168:171], v[196:199]
    v_mfma_f32_16x16x32_bf16 v[196:199], v[220:223], v[172:175], v[196:199]
    v_mfma_f32_16x16x32_bf16 v[196:199], v[224:227], v[176:179], v[196:199]
    v_mfma_f32_16x16x32_bf16 v[196:199], v[228:231], v[180:183], v[196:199]
    s_setprio 1
    s_nop 6
    s_nop 0
    v_cvt_pk_f16_f32 v200, v196, v197
    v_cvt_pk_f16_f32 v201, v198, v199
    v_pk_fma_f16 v204, v200, v200, s60
    v_pk_fma_f16 v205, v201, v201, s60
    v_pk_mul_f16 v200, v200, v204 neg_lo:[1,0] neg_hi:[1,0]
    v_pk_mul_f16 v201, v201, v205 neg_lo:[1,0] neg_hi:[1,0]
    v_exp_f16_sdwa v200, v200 dst_sel:WORD_0 dst_unused:UNUSED_PRESERVE src0_sel:WORD_0
    v_exp_f16_sdwa v201, v201 dst_sel:WORD_0 dst_unused:UNUSED_PRESERVE src0_sel:WORD_0
    v_exp_f16_sdwa v200, v200 dst_sel:WORD_1 dst_unused:UNUSED_PRESERVE src0_sel:WORD_1
    v_exp_f16_sdwa v201, v201 dst_sel:WORD_1 dst_unused:UNUSED_PRESERVE src0_sel:WORD_1
    v_pk_add_f16 v200, v200, s7
    v_pk_add_f16 v201, v201, s7
    v_rcp_f16_sdwa v200, v200 dst_sel:WORD_0 dst_unused:UNUSED_PRESERVE src0_sel:WORD_0
    v_rcp_f16_sdwa v201, v201 dst_sel:WORD_0 dst_unused:UNUSED_PRESERVE src0_sel:WORD_0
    v_rcp_f16_sdwa v200, v200 dst_sel:WORD_1 dst_unused:UNUSED_PRESERVE src0_sel:WORD_1
    v_rcp_f16_sdwa v201, v201 dst_sel:WORD_1 dst_unused:UNUSED_PRESERVE src0_sel:WORD_1
    v_fma_mix_f32 v196, v196, v200, 0 op_sel:[0,0,0] op_sel_hi:[0,1,0]
    v_fma_mix_f32 v197, v197, v200, 0 op_sel:[0,1,0] op_sel_hi:[0,1,0]
    v_fma_mix_f32 v198, v198, v201, 0 op_sel:[0,0,0] op_sel_hi:[0,1,0]
    v_fma_mix_f32 v199, v199, v201, 0 op_sel:[0,1,0] op_sel_hi:[0,1,0]
    v_cvt_pk_bf16_f32 v204, v196, v197
    v_cvt_pk_bf16_f32 v205, v198, v199
    v_add_u32 v4, 256, v4
    s_setprio 0
    s_add_u32 m0, s52, 1024
    s_nop 0
    buffer_load_dwordx4 v10, s[16:19], s41 offen lds
    ds_read_b128 v[48:51], v253 offset:256
    ds_read_b128 v[52:55], v253 offset:272
    ds_read_b128 v[56:59], v253 offset:320
    ds_read_b128 v[60:63], v253 offset:336
    s_waitcnt lgkmcnt(0)
    s_add_u32 m0, s52, 50176
    s_nop 0
    buffer_load_dwordx4 v11, s[20:23], s47 offen lds
    ds_read_b128 v[64:67], v253 offset:0
    ds_read_b128 v[68:71], v253 offset:16
    ds_read_b128 v[72:75], v253 offset:64
    ds_read_b128 v[76:79], v253 offset:80
    s_waitcnt lgkmcnt(0)
    s_add_u32 m0, s52, 2048
    s_nop 0
    buffer_load_dwordx4 v10, s[16:19], s42 offen lds
    ds_read_b128 v[80:83], v253 offset:128
    ds_read_b128 v[84:87], v253 offset:144
    ds_read_b128 v[88:91], v253 offset:192
    ds_read_b128 v[92:95], v253 offset:208
    s_waitcnt lgkmcnt(0)
    s_add_u32 m0, s52, 51200
    s_nop 0
    buffer_load_dwordx4 v11, s[20:23], s48 offen lds
    ds_read_b128 v[96:99], v253 offset:256
    ds_read_b128 v[100:103], v253 offset:272
    ds_read_b128 v[104:107], v253 offset:320
    ds_read_b128 v[108:111], v253 offset:336
    s_waitcnt lgkmcnt(0)
    ds_write_b64 v5, v[204:205] offset:0
    ds_read_b128 v[196:199], v4 offset:0
    ds_read_b64_tr_b16 v[208:209], v3 offset:24576
    ds_read_b64_tr_b16 v[210:211], v3 offset:25600
    ds_read_b64_tr_b16 v[212:213], v3 offset:28672
    ds_read_b64_tr_b16 v[214:215], v3 offset:29696
    ds_read_b64_tr_b16 v[216:217], v3 offset:32768
    ds_read_b64_tr_b16 v[218:219], v3 offset:33792
    ds_read_b64_tr_b16 v[220:221], v3 offset:36864
    ds_read_b64_tr_b16 v[222:223], v3 offset:37888
    ds_read_b64_tr_b16 v[224:225], v3 offset:40960
    ds_read_b64_tr_b16 v[226:227], v3 offset:41984
    ds_read_b64_tr_b16 v[228:229], v3 offset:45056
    ds_read_b64_tr_b16 v[230:231], v3 offset:46080
    s_waitcnt lgkmcnt(10)
    v_mfma_f32_16x16x32_bf16 v[196:199], v[208:211], v[160:163], v[196:199]
    s_waitcnt lgkmcnt(8)
    v_mfma_f32_16x16x32_bf16 v[196:199], v[212:215], v[164:167], v[196:199]
    s_waitcnt lgkmcnt(6)
    v_mfma_f32_16x16x32_bf16 v[196:199], v[216:219], v[168:171], v[196:199]
    s_waitcnt lgkmcnt(4)
    v_mfma_f32_16x16x32_bf16 v[196:199], v[220:223], v[172:175], v[196:199]
    s_waitcnt lgkmcnt(2)
    v_mfma_f32_16x16x32_bf16 v[196:199], v[224:227], v[176:179], v[196:199]
    s_waitcnt lgkmcnt(0)
    v_mfma_f32_16x16x32_bf16 v[196:199], v[228:231], v[180:183], v[196:199]
    s_setprio 1
    s_nop 6
    s_nop 0
    v_cvt_pk_f16_f32 v200, v196, v197
    v_cvt_pk_f16_f32 v201, v198, v199
    v_pk_fma_f16 v204, v200, v200, s60
    v_pk_fma_f16 v205, v201, v201, s60
    v_pk_mul_f16 v200, v200, v204 neg_lo:[1,0] neg_hi:[1,0]
    v_pk_mul_f16 v201, v201, v205 neg_lo:[1,0] neg_hi:[1,0]
    v_exp_f16_sdwa v200, v200 dst_sel:WORD_0 dst_unused:UNUSED_PRESERVE src0_sel:WORD_0
    v_exp_f16_sdwa v201, v201 dst_sel:WORD_0 dst_unused:UNUSED_PRESERVE src0_sel:WORD_0
    v_exp_f16_sdwa v200, v200 dst_sel:WORD_1 dst_unused:UNUSED_PRESERVE src0_sel:WORD_1
    v_exp_f16_sdwa v201, v201 dst_sel:WORD_1 dst_unused:UNUSED_PRESERVE src0_sel:WORD_1
    v_pk_add_f16 v200, v200, s7
    v_pk_add_f16 v201, v201, s7
    v_rcp_f16_sdwa v200, v200 dst_sel:WORD_0 dst_unused:UNUSED_PRESERVE src0_sel:WORD_0
    v_rcp_f16_sdwa v201, v201 dst_sel:WORD_0 dst_unused:UNUSED_PRESERVE src0_sel:WORD_0
    v_rcp_f16_sdwa v200, v200 dst_sel:WORD_1 dst_unused:UNUSED_PRESERVE src0_sel:WORD_1
    v_rcp_f16_sdwa v201, v201 dst_sel:WORD_1 dst_unused:UNUSED_PRESERVE src0_sel:WORD_1
    v_fma_mix_f32 v196, v196, v200, 0 op_sel:[0,0,0] op_sel_hi:[0,1,0]
    v_fma_mix_f32 v197, v197, v200, 0 op_sel:[0,1,0] op_sel_hi:[0,1,0]
    v_fma_mix_f32 v198, v198, v201, 0 op_sel:[0,0,0] op_sel_hi:[0,1,0]
    v_fma_mix_f32 v199, v199, v201, 0 op_sel:[0,1,0] op_sel_hi:[0,1,0]
    v_cvt_pk_bf16_f32 v204, v196, v197
    v_cvt_pk_bf16_f32 v205, v198, v199
    s_setprio 0
    s_add_u32 m0, s52, 3072
    s_nop 0
    buffer_load_dwordx4 v10, s[16:19], s43 offen lds
    ds_read_b128 v[112:115], v253 offset:0
    ds_read_b128 v[116:119], v253 offset:16
    ds_read_b128 v[120:123], v253 offset:64
    ds_read_b128 v[124:127], v253 offset:80
    s_waitcnt lgkmcnt(0)
    s_add_u32 m0, s52, 52224
    s_nop 0
    buffer_load_dwordx4 v11, s[20:23], s49 offen lds
    ds_read_b128 v[128:131], v253 offset:128
    ds_read_b128 v[132:135], v253 offset:144
    ds_read_b128 v[136:139], v253 offset:192
    ds_read_b128 v[140:143], v253 offset:208
    s_waitcnt lgkmcnt(0)
    s_add_u32 m0, s52, 4096
    s_nop 0
    buffer_load_dwordx4 v10, s[16:19], s44 offen lds
    ds_read_b128 v[144:147], v253 offset:256
    ds_read_b128 v[148:151], v253 offset:272
    ds_read_b128 v[152:155], v253 offset:320
    ds_read_b128 v[156:159], v253 offset:336
    s_waitcnt lgkmcnt(0)
    s_add_u32 m0, s52, 53248
    s_nop 0
    buffer_load_dwordx4 v11, s[20:23], s50 offen lds
    ds_read_b128 v[184:187], v254 offset:0
    ds_read_b128 v[188:191], v254 offset:64
    ds_read_b128 v[192:195], v254 offset:128
    s_waitcnt lgkmcnt(0)
    s_add_u32 m0, s52, 5120
    s_nop 0
    buffer_load_dwordx4 v10, s[16:19], s45 offen lds
    s_waitcnt lgkmcnt(0)
    s_add_u32 m0, s52, 54272
    s_nop 0
    buffer_load_dwordx4 v11, s[20:23], s51 offen lds
    s_waitcnt lgkmcnt(0)
    s_setprio 1
    v_add_u32 v10, 128, v10
    v_add_u32 v11, 24576, v11
    v_add_u32 v4, 256, v4
    s_setprio 0
    s_mov_b32 s61, 5
    s_waitcnt vmcnt(0) lgkmcnt(0)
    s_cmp_eq_u32 s6, 13
    s_cbranch_scc1 L_Qloop
.p2align 6
L_QloopN:
    s_barrier
    ds_read_b64_tr_b16 v[208:209], v1 offset:0
    ds_read_b64_tr_b16 v[210:211], v1 offset:3072
    ds_read_b128 v[212:215], v2 offset:0
    ds_read_b64_tr_b16 v[216:217], v1 offset:512
    ds_read_b64_tr_b16 v[218:219], v1 offset:3584
    ds_read_b128 v[220:223], v2 offset:4096
    ds_read_b64_tr_b16 v[224:225], v1 offset:1024
    ds_read_b64_tr_b16 v[226:227], v1 offset:4096
    ds_read_b128 v[228:231], v2 offset:8192
    ds_read_b64_tr_b16 v[232:233], v1 offset:6144
    ds_read_b64_tr_b16 v[234:235], v1 offset:9216
    ds_read_b128 v[236:239], v2 offset:1024
    ds_read_b64_tr_b16 v[240:241], v1 offset:6656
    ds_read_b64_tr_b16 v[242:243], v1 offset:9728
    ds_read_b128 v[244:247], v2 offset:5120
    ds_read_b64_tr_b16 v[248:249], v1 offset:7168
    ds_read_b64_tr_b16 v[250:251], v1 offset:10240
    ds_read_b128 v[252:255], v2 offset:9216
    s_waitcnt lgkmcnt(14)
    v_mfma_f32_32x32x16_bf16 v[16:31], v[208:211], v[212:215], v[16:31]
    s_waitcnt lgkmcnt(13)
    v_mfma_f32_32x32x16_bf16 v[32:47], v[216:219], v[212:215], v[32:47]
    s_waitcnt lgkmcnt(12)
    v_mfma_f32_32x32x16_bf16 v[64:79], v[208:211], v[220:223], v[64:79]
    v_mfma_f32_32x32x16_bf16 v[80:95], v[216:219], v[220:223], v[80:95]
    s_waitcnt lgkmcnt(10)
    v_mfma_f32_32x32x16_bf16 v[48:63], v[224:227], v[212:215], v[48:63]
    s_waitcnt lgkmcnt(9)
    s_add_u32 m0, s52, 24576
    s_nop 0
    buffer_load_dwordx4 v10, s[16:19], s40 offen lds
    v_mfma_f32_32x32x16_bf16 v[112:127], v[208:211], v[228:231], v[112:127]
    ds_read_b64_tr_b16 v[208:209], v1 offset:12288
    ds_read_b64_tr_b16 v[210:211], v1 offset:15360
    ds_read_b128 v[212:215], v2 offset:2048
    v_mfma_f32_32x32x16_bf16 v[96:111], v[224:227], v[220:223], v[96:111]
    s_add_u32 m0, s52, 73728
    s_nop 0
    buffer_load_dwordx4 v11, s[20:23], s46 offen lds
    v_mfma_f32_32x32x16_bf16 v[128:143], v[216:219], v[228:231], v[128:143]
    ds_read_b64_tr_b16 v[216:217], v1 offset:12800
    ds_read_b64_tr_b16 v[218:219], v1 offset:15872
    ds_read_b128 v[220:223], v2 offset:6144
    v_mfma_f32_32x32x16_bf16 v[144:159], v[224:227], v[228:231], v[144:159]
    s_waitcnt lgkmcnt(12)
    ds_read_b64_tr_b16 v[224:225], v1 offset:13312
    ds_read_b64_tr_b16 v[226:227], v1 offset:16384
    ds_read_b128 v[228:231], v2 offset:10240
    v_mfma_f32_32x32x16_bf16 v[16:31], v[232:235], v[236:239], v[16:31]
    s_waitcnt lgkmcnt(13)
    s_add_u32 m0, s52, 25600
    s_nop 0
    buffer_load_dwordx4 v10, s[16:19], s41 offen lds
    v_mfma_f32_32x32x16_bf16 v[32:47], v[240:243], v[236:239], v[32:47]
    s_waitcnt lgkmcnt(12)
    v_mfma_f32_32x32x16_bf16 v[64:79], v[232:235], v[244:247], v[64:79]
    s_add_u32 m0, s52, 74752
    s_nop 0
    buffer_load_dwordx4 v11, s[20:23], s47 offen lds
    v_mfma_f32_32x32x16_bf16 v[80:95], v[240:243], v[244:247], v[80:95]
    s_waitcnt lgkmcnt(10)
    v_mfma_f32_32x32x16_bf16 v[48:63], v[248:251], v[236:239], v[48:63]
    s_waitcnt lgkmcnt(9)
    s_add_u32 m0, s52, 26624
    s_nop 0
    buffer_load_dwordx4 v10, s[16:19], s42 offen lds
    v_mfma_f32_32x32x16_bf16 v[112:127], v[232:235], v[252:255], v[112:127]
    ds_read_b64_tr_b16 v[232:233], v1 offset:18432
    ds_read_b64_tr_b16 v[234:235], v1 offset:21504
    ds_read_b128 v[236:239], v2 offset:3072
    v_mfma_f32_32x32x16_bf16 v[96:111], v[248:251], v[244:247], v[96:111]
    s_add_u32 m0, s52, 75776
    s_nop 0
    buffer_load_dwordx4 v11, s[20:23], s48 offen lds
    v_mfma_f32_32x32x16_bf16 v[128:143], v[240:243], v[252:255], v[128:143]
    ds_read_b64_tr_b16 v[240:241], v1 offset:18944
    ds_read_b64_tr_b16 v[242:243], v1 offset:22016
    ds_read_b128 v[244:247], v2 offset:7168
    v_mfma_f32_32x32x16_bf16 v[144:159], v[248:251], v[252:255], v[144:159]
    s_waitcnt lgkmcnt(12)
    ds_read_b64_tr_b16 v[248:249], v1 offset:19456
    ds_read_b64_tr_b16 v[250:251], v1 offset:22528
    ds_read_b128 v[252:255], v2 offset:11264
    v_mfma_f32_32x32x16_bf16 v[16:31], v[208:211], v[212:215], v[16:31]
    s_waitcnt lgkmcnt(13)
    v_mfma_f32_32x32x16_bf16 v[32:47], v[216:219], v[212:215], v[32:47]
    s_waitcnt lgkmcnt(12)
    v_mfma_f32_32x32x16_bf16 v[64:79], v[208:211], v[220:223], v[64:79]
    s_add_u32 m0, s52, 27648
    s_nop 0
    buffer_load_dwordx4 v10, s[16:19], s43 offen lds
    v_mfma_f32_32x32x16_bf16 v[80:95], v[216:219], v[220:223], v[80:95]
    s_waitcnt lgkmcnt(10)
    s_add_u32 m0, s52, 76800
    s_nop 0
    buffer_load_dwordx4 v11, s[20:23], s49 offen lds
    v_mfma_f32_32x32x16_bf16 v[48:63], v[224:227], v[212:215], v[48:63]
    s_waitcnt lgkmcnt(9)
    s_add_u32 m0, s52, 28672
    s_nop 0
    buffer_load_dwordx4 v10, s[16:19], s44 offen lds
    v_mfma_f32_32x32x16_bf16 v[112:127], v[208:211], v[228:231], v[112:127]
    v_mfma_f32_32x32x16_bf16 v[96:111], v[224:227], v[220:223], v[96:111]
    s_add_u32 m0, s52, 77824
    s_nop 0
    buffer_load_dwordx4 v11, s[20:23], s50 offen lds
    v_mfma_f32_32x32x16_bf16 v[128:143], v[216:219], v[228:231], v[128:143]
    s_add_u32 m0, s52, 29696
    s_nop 0
    buffer_load_dwordx4 v10, s[16:19], s45 offen lds
    v_mfma_f32_32x32x16_bf16 v[144:159], v[224:227], v[228:231], v[144:159]
    s_waitcnt lgkmcnt(6)
    s_add_u32 m0, s52, 78848
    s_nop 0
    buffer_load_dwordx4 v11, s[20:23], s51 offen lds
    v_mfma_f32_32x32x16_bf16 v[16:31], v[232:235], v[236:239], v[16:31]
    s_waitcnt lgkmcnt(4)
    v_mfma_f32_32x32x16_bf16 v[32:47], v[240:243], v[236:239], v[32:47]
    s_waitcnt lgkmcnt(3)
    v_mfma_f32_32x32x16_bf16 v[64:79], v[232:235], v[244:247], v[64:79]
    v_mfma_f32_32x32x16_bf16 v[80:95], v[240:243], v[244:247], v[80:95]
    s_waitcnt lgkmcnt(1)
    s_setprio 1
    v_add_u32 v10, 128, v10
    v_add_u32 v11, 24576, v11
    v_add_u32 v4, 256, v4
    s_setprio 0
    v_mfma_f32_32x32x16_bf16 v[48:63], v[248:251], v[236:239], v[48:63]
    s_waitcnt lgkmcnt(0)
    v_mfma_f32_32x32x16_bf16 v[112:127], v[232:235], v[252:255], v[112:127]
    v_mfma_f32_32x32x16_bf16 v[96:111], v[248:251], v[244:247], v[96:111]
    v_mfma_f32_32x32x16_bf16 v[128:143], v[240:243], v[252:255], v[128:143]
    v_mfma_f32_32x32x16_bf16 v[144:159], v[248:251], v[252:255], v[144:159]
    s_waitcnt vmcnt(0) lgkmcnt(0)
    s_barrier
    ds_read_b64_tr_b16 v[208:209], v1 offset:24576
    ds_read_b64_tr_b16 v[210:211], v1 offset:27648
    ds_read_b128 v[212:215], v2 offset:24576
    ds_read_b64_tr_b16 v[216:217], v1 offset:25088
    ds_read_b64_tr_b16 v[218:219], v1 offset:28160
    ds_read_b128 v[220:223], v2 offset:28672
    ds_read_b64_tr_b16 v[224:225], v1 offset:25600
    ds_read_b64_tr_b16 v[226:227], v1 offset:28672
    ds_read_b128 v[228:231], v2 offset:32768
    ds_read_b64_tr_b16 v[232:233], v1 offset:30720
    ds_read_b64_tr_b16 v[234:235], v1 offset:33792
    ds_read_b128 v[236:239], v2 offset:25600
    ds_read_b64_tr_b16 v[240:241], v1 offset:31232
    ds_read_b64_tr_b16 v[242:243], v1 offset:34304
    ds_read_b128 v[244:247], v2 offset:29696
    ds_read_b64_tr_b16 v[248:249], v1 offset:31744
    ds_read_b64_tr_b16 v[250:251], v1 offset:34816
    ds_read_b128 v[252:255], v2 offset:33792
    s_waitcnt lgkmcnt(14)
    v_mfma_f32_32x32x16_bf16 v[16:31], v[208:211], v[212:215], v[16:31]
    s_waitcnt lgkmcnt(13)
    v_mfma_f32_32x32x16_bf16 v[32:47], v[216:219], v[212:215], v[32:47]
    s_waitcnt lgkmcnt(12)
    v_mfma_f32_32x32x16_bf16 v[64:79], v[208:211], v[220:223], v[64:79]
    v_mfma_f32_32x32x16_bf16 v[80:95], v[216:219], v[220:223], v[80:95]
    s_waitcnt lgkmcnt(10)
    v_mfma_f32_32x32x16_bf16 v[48:63], v[224:227], v[212:215], v[48:63]
    s_waitcnt lgkmcnt(9)
    s_add_u32 m0, s52, 0
    s_nop 0
    buffer_load_dwordx4 v10, s[16:19], s40 offen lds
    v_mfma_f32_32x32x16_bf16 v[112:127], v[208:211], v[228:231], v[112:127]
    ds_read_b64_tr_b16 v[208:209], v1 offset:36864
    ds_read_b64_tr_b16 v[210:211], v1 offset:39936
    ds_read_b128 v[212:215], v2 offset:26624
    v_mfma_f32_32x32x16_bf16 v[96:111], v[224:227], v[220:223], v[96:111]
    s_add_u32 m0, s52, 49152
    s_nop 0
    buffer_load_dwordx4 v11, s[20:23], s46 offen lds
    v_mfma_f32_32x32x16_bf16 v[128:143], v[216:219], v[228:231], v[128:143]
    ds_read_b64_tr_b16 v[216:217], v1 offset:37376
    ds_read_b64_tr_b16 v[218:219], v1 offset:40448
    ds_read_b128 v[220:223], v2 offset:30720
    v_mfma_f32_32x32x16_bf16 v[144:159], v[224:227], v[228:231], v[144:159]
    s_waitcnt lgkmcnt(12)
    ds_read_b64_tr_b16 v[224:225], v1 offset:37888
    ds_read_b64_tr_b16 v[226:227], v1 offset:40960
    ds_read_b128 v[228:231], v2 offset:34816
    v_mfma_f32_32x32x16_bf16 v[16:31], v[232:235], v[236:239], v[16:31]
    s_waitcnt lgkmcnt(13)
    s_add_u32 m0, s52, 1024
    s_nop 0
    buffer_load_dwordx4 v10, s[16:19], s41 offen lds
    v_mfma_f32_32x32x16_bf16 v[32:47], v[240:243], v[236:239], v[32:47]
    s_waitcnt lgkmcnt(12)
    v_mfma_f32_32x32x16_bf16 v[64:79], v[232:235], v[244:247], v[64:79]
    s_add_u32 m0, s52, 50176
    s_nop 0
    buffer_load_dwordx4 v11, s[20:23], s47 offen lds
    v_mfma_f32_32x32x16_bf16 v[80:95], v[240:243], v[244:247], v[80:95]
    s_waitcnt lgkmcnt(10)
    v_mfma_f32_32x32x16_bf16 v[48:63], v[248:251], v[236:239], v[48:63]
    s_waitcnt lgkmcnt(9)
    s_add_u32 m0, s52, 2048
    s_nop 0
    buffer_load_dwordx4 v10, s[16:19], s42 offen lds
    v_mfma_f32_32x32x16_bf16 v[112:127], v[232:235], v[252:255], v[112:127]
    ds_read_b64_tr_b16 v[232:233], v1 offset:43008
    ds_read_b64_tr_b16 v[234:235], v1 offset:46080
    ds_read_b128 v[236:239], v2 offset:27648
    v_mfma_f32_32x32x16_bf16 v[96:111], v[248:251], v[244:247], v[96:111]
    s_add_u32 m0, s52, 51200
    s_nop 0
    buffer_load_dwordx4 v11, s[20:23], s48 offen lds
    v_mfma_f32_32x32x16_bf16 v[128:143], v[240:243], v[252:255], v[128:143]
    ds_read_b64_tr_b16 v[240:241], v1 offset:43520
    ds_read_b64_tr_b16 v[242:243], v1 offset:46592
    ds_read_b128 v[244:247], v2 offset:31744
    v_mfma_f32_32x32x16_bf16 v[144:159], v[248:251], v[252:255], v[144:159]
    s_waitcnt lgkmcnt(12)
    ds_read_b64_tr_b16 v[248:249], v1 offset:44032
    ds_read_b64_tr_b16 v[250:251], v1 offset:47104
    ds_read_b128 v[252:255], v2 offset:35840
    v_mfma_f32_32x32x16_bf16 v[16:31], v[208:211], v[212:215], v[16:31]
    s_waitcnt lgkmcnt(13)
    v_mfma_f32_32x32x16_bf16 v[32:47], v[216:219], v[212:215], v[32:47]
    s_waitcnt lgkmcnt(12)
    v_mfma_f32_32x32x16_bf16 v[64:79], v[208:211], v[220:223], v[64:79]
    s_add_u32 m0, s52, 3072
    s_nop 0
    buffer_load_dwordx4 v10, s[16:19], s43 offen lds
    v_mfma_f32_32x32x16_bf16 v[80:95], v[216:219], v[220:223], v[80:95]
    s_waitcnt lgkmcnt(10)
    s_add_u32 m0, s52, 52224
    s_nop 0
    buffer_load_dwordx4 v11, s[20:23], s49 offen lds
    v_mfma_f32_32x32x16_bf16 v[48:63], v[224:227], v[212:215], v[48:63]
    s_waitcnt lgkmcnt(9)
    s_add_u32 m0, s52, 4096
    s_nop 0
    buffer_load_dwordx4 v10, s[16:19], s44 offen lds
    v_mfma_f32_32x32x16_bf16 v[112:127], v[208:211], v[228:231], v[112:127]
    v_mfma_f32_32x32x16_bf16 v[96:111], v[224:227], v[220:223], v[96:111]
    s_add_u32 m0, s52, 53248
    s_nop 0
    buffer_load_dwordx4 v11, s[20:23], s50 offen lds
    v_mfma_f32_32x32x16_bf16 v[128:143], v[216:219], v[228:231], v[128:143]
    s_add_u32 m0, s52, 5120
    s_nop 0
    buffer_load_dwordx4 v10, s[16:19], s45 offen lds
    v_mfma_f32_32x32x16_bf16 v[144:159], v[224:227], v[228:231], v[144:159]
    s_waitcnt lgkmcnt(6)
    s_add_u32 m0, s52, 54272
    s_nop 0
    buffer_load_dwordx4 v11, s[20:23], s51 offen lds
    v_mfma_f32_32x32x16_bf16 v[16:31], v[232:235], v[236:239], v[16:31]
    s_waitcnt lgkmcnt(4)
    v_mfma_f32_32x32x16_bf16 v[32:47], v[240:243], v[236:239], v[32:47]
    s_waitcnt lgkmcnt(3)
    v_mfma_f32_32x32x16_bf16 v[64:79], v[232:235], v[244:247], v[64:79]
    v_mfma_f32_32x32x16_bf16 v[80:95], v[240:243], v[244:247], v[80:95]
    s_waitcnt lgkmcnt(1)
    s_setprio 1
    v_add_u32 v10, 128, v10
    v_add_u32 v11, 24576, v11
    v_add_u32 v4, 256, v4
    s_setprio 0
    v_mfma_f32_32x32x16_bf16 v[48:63], v[248:251], v[236:239], v[48:63]
    s_waitcnt lgkmcnt(0)
    v_mfma_f32_32x32x16_bf16 v[112:127], v[232:235], v[252:255], v[112:127]
    v_mfma_f32_32x32x16_bf16 v[96:111], v[248:251], v[244:247], v[96:111]
    v_mfma_f32_32x32x16_bf16 v[128:143], v[240:243], v[252:255], v[128:143]
    v_mfma_f32_32x32x16_bf16 v[144:159], v[248:251], v[252:255], v[144:159]
    s_sub_u32 s61, s61, 1
    s_cmp_lg_u32 s61, 0
    s_waitcnt vmcnt(0) lgkmcnt(0)
    s_cbranch_scc1 L_QloopN
    s_branch L_Qpost
.p2align 6
L_Qloop:
    s_barrier
    ds_write_b64 v5, v[204:205] offset:2048
    ds_read_b128 v[196:199], v4 offset:0
    ds_read_b64_tr_b16 v[208:209], v1 offset:0
    ds_read_b64_tr_b16 v[210:211], v1 offset:3072
    ds_read_b128 v[212:215], v2 offset:0
    ds_read_b64_tr_b16 v[216:217], v1 offset:512
    ds_read_b64_tr_b16 v[218:219], v1 offset:3584
    ds_read_b128 v[220:223], v2 offset:4096
    ds_read_b64_tr_b16 v[224:225], v1 offset:1024
    ds_read_b64_tr_b16 v[226:227], v1 offset:4096
    ds_read_b128 v[228:231], v2 offset:8192
    ds_read_b64_tr_b16 v[232:233], v1 offset:6144
    ds_read_b64_tr_b16 v[234:235], v1 offset:9216
    ds_read_b128 v[236:239], v2 offset:1024
    ds_read_b64_tr_b16 v[240:241], v1 offset:6656
    ds_read_b64_tr_b16 v[242:243], v1 offset:9728
    ds_read_b128 v[244:247], v2 offset:5120
    ds_read_b64_tr_b16 v[248:249], v1 offset:7168
    ds_read_b64_tr_b16 v[250:251], v1 offset:10240
    ds_read_b128 v[252:255], v2 offset:9216
    s_waitcnt lgkmcnt(14)
    v_mfma_f32_32x32x16_bf16 v[16:31], v[208:211], v[212:215], v[16:31]
    s_waitcnt lgkmcnt(13)
    v_mfma_f32_32x32x16_bf16 v[32:47], v[216:219], v[212:215], v[32:47]
    s_waitcnt lgkmcnt(12)
    v_mfma_f32_32x32x16_bf16 v[64:79], v[208:211], v[220:223], v[64:79]
    v_mfma_f32_32x32x16_bf16 v[80:95], v[216:219], v[220:223], v[80:95]
    s_waitcnt lgkmcnt(10)
    v_mfma_f32_32x32x16_bf16 v[48:63], v[224:227], v[212:215], v[48:63]
    s_waitcnt lgkmcnt(9)
    s_add_u32 m0, s52, 24576
    s_nop 0
    buffer_load_dwordx4 v10, s[16:19], s40 offen lds
    v_mfma_f32_32x32x16_bf16 v[112:127], v[208:211], v[228:231], v[112:127]
    ds_read_b64_tr_b16 v[208:209], v1 offset:12288
    ds_read_b64_tr_b16 v[210:211], v1 offset:15360
    ds_read_b128 v[212:215], v2 offset:2048
    v_mfma_f32_32x32x16_bf16 v[96:111], v[224:227], v[220:223], v[96:111]
    s_add_u32 m0, s52, 73728
    s_nop 0
    buffer_load_dwordx4 v11, s[20:23], s46 offen lds
    v_mfma_f32_32x32x16_bf16 v[128:143], v[216:219], v[228:231], v[128:143]
    ds_read_b64_tr_b16 v[216:217], v1 offset:12800
    ds_read_b64_tr_b16 v[218:219], v1 offset:15872
    ds_read_b128 v[220:223], v2 offset:6144
    v_mfma_f32_32x32x16_bf16 v[144:159], v[224:227], v[228:231], v[144:159]
    s_waitcnt lgkmcnt(12)
    ds_read_b64_tr_b16 v[224:225], v1 offset:13312
    ds_read_b64_tr_b16 v[226:227], v1 offset:16384
    ds_read_b128 v[228:231], v2 offset:10240
    v_mfma_f32_32x32x16_bf16 v[16:31], v[232:235], v[236:239], v[16:31]
    s_waitcnt lgkmcnt(13)
    s_add_u32 m0, s52, 25600
    s_nop 0
    buffer_load_dwordx4 v10, s[16:19], s41 offen lds
    v_mfma_f32_32x32x16_bf16 v[32:47], v[240:243], v[236:239], v[32:47]
    s_waitcnt lgkmcnt(12)
    v_mfma_f32_32x32x16_bf16 v[64:79], v[232:235], v[244:247], v[64:79]
    s_add_u32 m0, s52, 74752
    s_nop 0
    buffer_load_dwordx4 v11, s[20:23], s47 offen lds
    v_mfma_f32_32x32x16_bf16 v[80:95], v[240:243], v[244:247], v[80:95]
    s_waitcnt lgkmcnt(10)
    v_mfma_f32_32x32x16_bf16 v[48:63], v[248:251], v[236:239], v[48:63]
    s_waitcnt lgkmcnt(9)
    s_add_u32 m0, s52, 26624
    s_nop 0
    buffer_load_dwordx4 v10, s[16:19], s42 offen lds
    v_mfma_f32_32x32x16_bf16 v[112:127], v[232:235], v[252:255], v[112:127]
    ds_read_b64_tr_b16 v[232:233], v3 offset:0
    ds_read_b64_tr_b16 v[234:235], v3 offset:1024
    ds_read_b64_tr_b16 v[236:237], v3 offset:4096
    ds_read_b64_tr_b16 v[238:239], v3 offset:5120
    v_mfma_f32_32x32x16_bf16 v[96:111], v[248:251], v[244:247], v[96:111]
    s_add_u32 m0, s52, 75776
    s_nop 0
    buffer_load_dwordx4 v11, s[20:23], s48 offen lds
    v_mfma_f32_32x32x16_bf16 v[128:143], v[240:243], v[252:255], v[128:143]
    ds_read_b64_tr_b16 v[240:241], v3 offset:8192
    ds_read_b64_tr_b16 v[242:243], v3 offset:9216
    ds_read_b64_tr_b16 v[244:245], v3 offset:12288
    ds_read_b64_tr_b16 v[246:247], v3 offset:13312
    v_mfma_f32_32x32x16_bf16 v[144:159], v[248:251], v[252:255], v[144:159]
    s_waitcnt lgkmcnt(14)
    ds_read_b64_tr_b16 v[248:249], v3 offset:16384
    ds_read_b64_tr_b16 v[250:251], v3 offset:17408
    ds_read_b64_tr_b16 v[252:253], v3 offset:20480
    ds_read_b64_tr_b16 v[254:255], v3 offset:21504
    v_mfma_f32_32x32x16_bf16 v[16:31], v[208:211], v[212:215], v[16:31]
    s_waitcnt lgkmcnt(14)
    v_mfma_f32_32x32x16_bf16 v[32:47], v[216:219], v[212:215], v[32:47]
    v_mfma_f32_32x32x16_bf16 v[64:79], v[208:211], v[220:223], v[64:79]
    v_mfma_f32_32x32x16_bf16 v[80:95], v[216:219], v[220:223], v[80:95]
    s_waitcnt lgkmcnt(13)
    s_add_u32 m0, s52, 27648
    s_nop 0
    buffer_load_dwordx4 v10, s[16:19], s43 offen lds
    v_mfma_f32_32x32x16_bf16 v[48:63], v[224:227], v[212:215], v[48:63]
    s_waitcnt lgkmcnt(12)
    s_add_u32 m0, s52, 76800
    s_nop 0
    buffer_load_dwordx4 v11, s[20:23], s49 offen lds
    v_mfma_f32_32x32x16_bf16 v[112:127], v[208:211], v[228:231], v[112:127]
    ds_read_b64_tr_b16 v[208:209], v1 offset:18432
    ds_read_b64_tr_b16 v[210:211], v1 offset:21504
    ds_read_b128 v[212:215], v2 offset:3072
    v_mfma_f32_32x32x16_bf16 v[96:111], v[224:227], v[220:223], v[96:111]
    s_add_u32 m0, s52, 28672
    s_nop 0
    buffer_load_dwordx4 v10, s[16:19], s44 offen lds
    v_mfma_f32_32x32x16_bf16 v[128:143], v[216:219], v[228:231], v[128:143]
    ds_read_b64_tr_b16 v[216:217], v1 offset:18944
    ds_read_b64_tr_b16 v[218:219], v1 offset:22016
    ds_read_b128 v[220:223], v2 offset:7168
    v_mfma_f32_32x32x16_bf16 v[144:159], v[224:227], v[228:231], v[144:159]
    s_waitcnt lgkmcnt(14)
    ds_read_b64_tr_b16 v[224:225], v1 offset:19456
    ds_read_b64_tr_b16 v[226:227], v1 offset:22528
    ds_read_b128 v[228:231], v2 offset:11264
    s_add_u32 m0, s52, 77824
    s_nop 0
    buffer_load_dwordx4 v11, s[20:23], s50 offen lds
    v_mfma_f32_16x16x32_bf16 v[196:199], v[232:235], v[160:163], v[196:199]
    v_mfma_f32_16x16x32_bf16 v[196:199], v[236:239], v[164:167], v[196:199]
    s_waitcnt lgkmcnt(14)
    v_mfma_f32_16x16x32_bf16 v[196:199], v[240:243], v[168:171], v[196:199]
    s_waitcnt lgkmcnt(13)
    s_add_u32 m0, s52, 29696
    s_nop 0
    buffer_load_dwordx4 v10, s[16:19], s45 offen lds
    v_mfma_f32_16x16x32_bf16 v[196:199], v[244:247], v[172:175], v[196:199]
    s_waitcnt lgkmcnt(11)
    v_mfma_f32_16x16x32_bf16 v[196:199], v[248:251], v[176:179], v[196:199]
    s_waitcnt lgkmcnt(9)
    v_mfma_f32_16x16x32_bf16 v[196:199], v[252:255], v[180:183], v[196:199]
    s_waitcnt lgkmcnt(6)
    ds_read_b128 v[232:235], v6 offset:0
    ds_read_b64_tr_b16 v[236:237], v7 offset:0
    ds_read_b64_tr_b16 v[238:239], v7 offset:3072
    ds_read_b64_tr_b16 v[240:241], v8 offset:0
    ds_read_b64_tr_b16 v[242:243], v8 offset:3072
    ds_read_b64_tr_b16 v[244:245], v7 offset:512
    ds_read_b64_tr_b16 v[246:247], v7 offset:3584
    ds_read_b128 v[248:251], v6 offset:1024
    ds_read_b64_tr_b16 v[252:253], v7 offset:12288
    ds_read_b64_tr_b16 v[254:255], v7 offset:15360
    s_add_u32 m0, s52, 78848
    s_nop 0
    buffer_load_dwordx4 v11, s[20:23], s51 offen lds
    v_mfma_f32_32x32x16_bf16 v[16:31], v[208:211], v[212:215], v[16:31]
    s_waitcnt lgkmcnt(14)
    v_mfma_f32_32x32x16_bf16 v[32:47], v[216:219], v[212:215], v[32:47]
    s_waitcnt lgkmcnt(13)
    s_setprio 1
    v_cvt_pk_f16_f32 v200, v196, v197
    v_cvt_pk_f16_f32 v201, v198, v199
    v_pk_fma_f16 v204, v200, v200, s60
    v_pk_fma_f16 v205, v201, v201, s60
    s_setprio 0
    v_mfma_f32_32x32x16_bf16 v[64:79], v[208:211], v[220:223], v[64:79]
    s_setprio 1
    v_pk_mul_f16 v200, v200, v204 neg_lo:[1,0] neg_hi:[1,0]
    v_pk_mul_f16 v201, v201, v205 neg_lo:[1,0] neg_hi:[1,0]
    v_exp_f16_sdwa v200, v200 dst_sel:WORD_0 dst_unused:UNUSED_PRESERVE src0_sel:WORD_0
    s_setprio 0
    v_mfma_f32_32x32x16_bf16 v[80:95], v[216:219], v[220:223], v[80:95]
    s_waitcnt lgkmcnt(11)
    s_setprio 1
    v_exp_f16_sdwa v201, v201 dst_sel:WORD_0 dst_unused:UNUSED_PRESERVE src0_sel:WORD_0
    v_exp_f16_sdwa v200, v200 dst_sel:WORD_1 dst_unused:UNUSED_PRESERVE src0_sel:WORD_1
    s_setprio 0
    v_mfma_f32_32x32x16_bf16 v[48:63], v[224:227], v[212:215], v[48:63]
    s_waitcnt lgkmcnt(10)
    s_setprio 1
    v_exp_f16_sdwa v201, v201 dst_sel:WORD_1 dst_unused:UNUSED_PRESERVE src0_sel:WORD_1
    v_pk_add_f16 v200, v200, s7
    v_pk_add_f16 v201, v201, s7
    s_setprio 0
    v_mfma_f32_32x32x16_bf16 v[112:127], v[208:211], v[228:231], v[112:127]
    ds_read_b64_tr_b16 v[208:209], v8 offset:12288
    ds_read_b64_tr_b16 v[210:211], v8 offset:15360
    ds_read_b64_tr_b16 v[212:213], v7 offset:12800
    ds_read_b64_tr_b16 v[214:215], v7 offset:15872
    s_setprio 1
    v_rcp_f16_sdwa v200, v200 dst_sel:WORD_0 dst_unused:UNUSED_PRESERVE src0_sel:WORD_0
    v_rcp_f16_sdwa v201, v201 dst_sel:WORD_0 dst_unused:UNUSED_PRESERVE src0_sel:WORD_0
    s_setprio 0
    v_mfma_f32_32x32x16_bf16 v[96:111], v[224:227], v[220:223], v[96:111]
    s_setprio 1
    v_rcp_f16_sdwa v200, v200 dst_sel:WORD_1 dst_unused:UNUSED_PRESERVE src0_sel:WORD_1
    v_rcp_f16_sdwa v201, v201 dst_sel:WORD_1 dst_unused:UNUSED_PRESERVE src0_sel:WORD_1
    s_setprio 0
    v_mfma_f32_32x32x16_bf16 v[128:143], v[216:219], v[228:231], v[128:143]
    s_setprio 1
    v_fma_mix_f32 v196, v196, v200, 0 op_sel:[0,0,0] op_sel_hi:[0,1,0]
    v_fma_mix_f32 v197, v197, v200, 0 op_sel:[0,1,0] op_sel_hi:[0,1,0]
    v_fma_mix_f32 v198, v198, v201, 0 op_sel:[0,0,0] op_sel_hi:[0,1,0]
    v_fma_mix_f32 v199, v199, v201, 0 op_sel:[0,1,0] op_sel_hi:[0,1,0]
    s_setprio 0
    v_mfma_f32_32x32x16_bf16 v[144:159], v[224:227], v[228:231], v[144:159]
    s_waitcnt lgkmcnt(11)
    s_setprio 1
    v_cvt_pk_bf16_f32 v204, v196, v197
    v_cvt_pk_bf16_f32 v205, v198, v199
    v_add_u32 v10, 128, v10
    v_add_u32 v11, 24576, v11
    v_add_u32 v4, 256, v4
    s_setprio 0
    v_mfma_f32_16x16x32_bf16 v[184:187], v[236:239], v[232:235], v[184:187]
    s_waitcnt lgkmcnt(9)
    v_mfma_f32_16x16x32_bf16 v[188:191], v[240:243], v[232:235], v[188:191]
    s_waitcnt lgkmcnt(7)
    v_mfma_f32_16x16x32_bf16 v[192:195], v[244:247], v[232:235], v[192:195]
    s_waitcnt lgkmcnt(4)
    v_mfma_f32_16x16x32_bf16 v[184:187], v[252:255], v[248:251], v[184:187]
    s_waitcnt lgkmcnt(2)
    v_mfma_f32_16x16x32_bf16 v[188:191], v[208:211], v[248:251], v[188:191]
    s_waitcnt lgkmcnt(0)
    v_mfma_f32_16x16x32_bf16 v[192:195], v[212:215], v[248:251], v[192:195]
    s_waitcnt vmcnt(0) lgkmcnt(0)
    s_barrier
    ds_write_b64 v5, v[204:205] offset:0
    ds_read_b128 v[196:199], v4 offset:0
    ds_read_b64_tr_b16 v[208:209], v1 offset:24576
    ds_read_b64_tr_b16 v[210:211], v1 offset:27648
    ds_read_b128 v[212:215], v2 offset:24576
    ds_read_b64_tr_b16 v[216:217], v1 offset:25088
    ds_read_b64_tr_b16 v[218:219], v1 offset:28160
    ds_read_b128 v[220:223], v2 offset:28672
    ds_read_b64_tr_b16 v[224:225], v1 offset:25600
    ds_read_b64_tr_b16 v[226:227], v1 offset:28672
    ds_read_b128 v[228:231], v2 offset:32768
    ds_read_b64_tr_b16 v[232:233], v1 offset:30720
    ds_read_b64_tr_b16 v[234:235], v1 offset:33792
    ds_read_b128 v[236:239], v2 offset:25600
    ds_read_b64_tr_b16 v[240:241], v1 offset:31232
    ds_read_b64_tr_b16 v[242:243], v1 offset:34304
    ds_read_b128 v[244:247], v2 offset:29696
    ds_read_b64_tr_b16 v[248:249], v1 offset:31744
    ds_read_b64_tr_b16 v[250:251], v1 offset:34816
    ds_read_b128 v[252:255], v2 offset:33792
    s_waitcnt lgkmcnt(14)
    v_mfma_f32_32x32x16_bf16 v[16:31], v[208:211], v[212:215], v[16:31]
    s_waitcnt lgkmcnt(13)
    v_mfma_f32_32x32x16_bf16 v[32:47], v[216:219], v[212:215], v[32:47]
    s_waitcnt lgkmcnt(12)
    v_mfma_f32_32x32x16_bf16 v[64:79], v[208:211], v[220:223], v[64:79]
    v_mfma_f32_32x32x16_bf16 v[80:95], v[216:219], v[220:223], v[80:95]
    s_waitcnt lgkmcnt(10)
    v_mfma_f32_32x32x16_bf16 v[48:63], v[224:227], v[212:215], v[48:63]
    s_waitcnt lgkmcnt(9)
    s_add_u32 m0, s52, 0
    s_nop 0
    buffer_load_dwordx4 v10, s[16:19], s40 offen lds
    v_mfma_f32_32x32x16_bf16 v[112:127], v[208:211], v[228:231], v[112:127]
    ds_read_b64_tr_b16 v[208:209], v1 offset:36864
    ds_read_b64_tr_b16 v[210:211], v1 offset:39936
    ds_read_b128 v[212:215], v2 offset:26624
    v_mfma_f32_32x32x16_bf16 v[96:111], v[224:227], v[220:223], v[96:111]
    s_add_u32 m0, s52, 49152
    s_nop 0
    buffer_load_dwordx4 v11, s[20:23], s46 offen lds
    v_mfma_f32_32x32x16_bf16 v[128:143], v[216:219], v[228:231], v[128:143]
    ds_read_b64_tr_b16 v[216:217], v1 offset:37376
    ds_read_b64_tr_b16 v[218:219], v1 offset:40448
    ds_read_b128 v[220:223], v2 offset:30720
    v_mfma_f32_32x32x16_bf16 v[144:159], v[224:227], v[228:231], v[144:159]
    s_waitcnt lgkmcnt(12)
    ds_read_b64_tr_b16 v[224:225], v1 offset:37888
    ds_read_b64_tr_b16 v[226:227], v1 offset:40960
    ds_read_b128 v[228:231], v2 offset:34816
    v_mfma_f32_32x32x16_bf16 v[16:31], v[232:235], v[236:239], v[16:31]
    s_waitcnt lgkmcnt(13)
    s_add_u32 m0, s52, 1024
    s_nop 0
    buffer_load_dwordx4 v10, s[16:19], s41 offen lds
    v_mfma_f32_32x32x16_bf16 v[32:47], v[240:243], v[236:239], v[32:47]
    s_waitcnt lgkmcnt(12)
    v_mfma_f32_32x32x16_bf16 v[64:79], v[232:235], v[244:247], v[64:79]
    s_add_u32 m0, s52, 50176
    s_nop 0
    buffer_load_dwordx4 v11, s[20:23], s47 offen lds
    v_mfma_f32_32x32x16_bf16 v[80:95], v[240:243], v[244:247], v[80:95]
    s_waitcnt lgkmcnt(10)
    v_mfma_f32_32x32x16_bf16 v[48:63], v[248:251], v[236:239], v[48:63]
    s_waitcnt lgkmcnt(9)
    s_add_u32 m0, s52, 2048
    s_nop 0
    buffer_load_dwordx4 v10, s[16:19], s42 offen lds
    v_mfma_f32_32x32x16_bf16 v[112:127], v[232:235], v[252:255], v[112:127]
    ds_read_b64_tr_b16 v[232:233], v3 offset:24576
    ds_read_b64_tr_b16 v[234:235], v3 offset:25600
    ds_read_b64_tr_b16 v[236:237], v3 offset:28672
    ds_read_b64_tr_b16 v[238:239], v3 offset:29696
    v_mfma_f32_32x32x16_bf16 v[96:111], v[248:251], v[244:247], v[96:111]
    s_add_u32 m0, s52, 51200
    s_nop 0
    buffer_load_dwordx4 v11, s[20:23], s48 offen lds
    v_mfma_f32_32x32x16_bf16 v[128:143], v[240:243], v[252:255], v[128:143]
    ds_read_b64_tr_b16 v[240:241], v3 offset:32768
    ds_read_b64_tr_b16 v[242:243], v3 offset:33792
    ds_read_b64_tr_b16 v[244:245], v3 offset:36864
    ds_read_b64_tr_b16 v[246:247], v3 offset:37888
    v_mfma_f32_32x32x16_bf16 v[144:159], v[248:251], v[252:255], v[144:159]
    s_waitcnt lgkmcnt(14)
    ds_read_b64_tr_b16 v[248:249], v3 offset:40960
    ds_read_b64_tr_b16 v[250:251], v3 offset:41984
    ds_read_b64_tr_b16 v[252:253], v3 offset:45056
    ds_read_b64_tr_b16 v[254:255], v3 offset:46080
    v_mfma_f32_32x32x16_bf16 v[16:31], v[208:211], v[212:215], v[16:31]
    s_waitcnt lgkmcnt(14)
    v_mfma_f32_32x32x16_bf16 v[32:47], v[216:219], v[212:215], v[32:47]
    v_mfma_f32_32x32x16_bf16 v[64:79], v[208:211], v[220:223], v[64:79]
    v_mfma_f32_32x32x16_bf16 v[80:95], v[216:219], v[220:223], v[80:95]
    s_waitcnt lgkmcnt(13)
    s_add_u32 m0, s52, 3072
    s_nop 0
    buffer_load_dwordx4 v10, s[16:19], s43 offen lds
    v_mfma_f32_32x32x16_bf16 v[48:63], v[224:227], v[212:215], v[48:63]
    s_waitcnt lgkmcnt(12)
    s_add_u32 m0, s52, 52224
    s_nop 0
    buffer_load_dwordx4 v11, s[20:23], s49 offen lds
    v_mfma_f32_32x32x16_bf16 v[112:127], v[208:211], v[228:231], v[112:127]
    ds_read_b64_tr_b16 v[208:209], v1 offset:43008
    ds_read_b64_tr_b16 v[210:211], v1 offset:46080
    ds_read_b128 v[212:215], v2 offset:27648
    v_mfma_f32_32x32x16_bf16 v[96:111], v[224:227], v[220:223], v[96:111]
    s_add_u32 m0, s52, 4096
    s_nop 0
    buffer_load_dwordx4 v10, s[16:19], s44 offen lds
    v_mfma_f32_32x32x16_bf16 v[128:143], v[216:219], v[228:231], v[128:143]
    ds_read_b64_tr_b16 v[216:217], v1 offset:43520
    ds_read_b64_tr_b16 v[218:219], v1 offset:46592
    ds_read_b128 v[220:223], v2 offset:31744
    v_mfma_f32_32x32x16_bf16 v[144:159], v[224:227], v[228:231], v[144:159]
    s_waitcnt lgkmcnt(14)
    ds_read_b64_tr_b16 v[224:225], v1 offset:44032
    ds_read_b64_tr_b16 v[226:227], v1 offset:47104
    ds_read_b128 v[228:231], v2 offset:35840
    s_add_u32 m0, s52, 53248
    s_nop 0
    buffer_load_dwordx4 v11, s[20:23], s50 offen lds
    v_mfma_f32_16x16x32_bf16 v[196:199], v[232:235], v[160:163], v[196:199]
    v_mfma_f32_16x16x32_bf16 v[196:199], v[236:239], v[164:167], v[196:199]
    s_waitcnt lgkmcnt(14)
    v_mfma_f32_16x16x32_bf16 v[196:199], v[240:243], v[168:171], v[196:199]
    s_waitcnt lgkmcnt(13)
    s_add_u32 m0, s52, 5120
    s_nop 0
    buffer_load_dwordx4 v10, s[16:19], s45 offen lds
    v_mfma_f32_16x16x32_bf16 v[196:199], v[244:247], v[172:175], v[196:199]
    s_waitcnt lgkmcnt(11)
    v_mfma_f32_16x16x32_bf16 v[196:199], v[248:251], v[176:179], v[196:199]
    s_waitcnt lgkmcnt(9)
    v_mfma_f32_16x16x32_bf16 v[196:199], v[252:255], v[180:183], v[196:199]
    s_waitcnt lgkmcnt(6)
    ds_read_b128 v[232:235], v6 offset:2048
    ds_read_b64_tr_b16 v[236:237], v7 offset:24576
    ds_read_b64_tr_b16 v[238:239], v7 offset:27648
    ds_read_b64_tr_b16 v[240:241], v8 offset:24576
    ds_read_b64_tr_b16 v[242:243], v8 offset:27648
    ds_read_b64_tr_b16 v[244:245], v7 offset:25088
    ds_read_b64_tr_b16 v[246:247], v7 offset:28160
    ds_read_b128 v[248:251], v6 offset:3072
    ds_read_b64_tr_b16 v[252:253], v7 offset:36864
    ds_read_b64_tr_b16 v[254:255], v7 offset:39936
    s_add_u32 m0, s52, 54272
    s_nop 0
    buffer_load_dwordx4 v11, s[20:23], s51 offen lds
    v_mfma_f32_32x32x16_bf16 v[16:31], v[208:211], v[212:215], v[16:31]
    s_waitcnt lgkmcnt(14)
    v_mfma_f32_32x32x16_bf16 v[32:47], v[216:219], v[212:215], v[32:47]
    s_waitcnt lgkmcnt(13)
    s_setprio 1
    v_cvt_pk_f16_f32 v200, v196, v197
    v_cvt_pk_f16_f32 v201, v198, v199
    v_pk_fma_f16 v204, v200, v200, s60
    v_pk_fma_f16 v205, v201, v201, s60
    s_setprio 0
    v_mfma_f32_32x32x16_bf16 v[64:79], v[208:211], v[220:223], v[64:79]
    s_setprio 1
    v_pk_mul_f16 v200, v200, v204 neg_lo:[1,0] neg_hi:[1,0]
    v_pk_mul_f16 v201, v201, v205 neg_lo:[1,0] neg_hi:[1,0]
    v_exp_f16_sdwa v200, v200 dst_sel:WORD_0 dst_unused:UNUSED_PRESERVE src0_sel:WORD_0
    s_setprio 0
    v_mfma_f32_32x32x16_bf16 v[80:95], v[216:219], v[220:223], v[80:95]
    s_waitcnt lgkmcnt(11)
    s_setprio 1
    v_exp_f16_sdwa v201, v201 dst_sel:WORD_0 dst_unused:UNUSED_PRESERVE src0_sel:WORD_0
    v_exp_f16_sdwa v200, v200 dst_sel:WORD_1 dst_unused:UNUSED_PRESERVE src0_sel:WORD_1
    s_setprio 0
    v_mfma_f32_32x32x16_bf16 v[48:63], v[224:227], v[212:215], v[48:63]
    s_waitcnt lgkmcnt(10)
    s_setprio 1
    v_exp_f16_sdwa v201, v201 dst_sel:WORD_1 dst_unused:UNUSED_PRESERVE src0_sel:WORD_1
    v_pk_add_f16 v200, v200, s7
    v_pk_add_f16 v201, v201, s7
    s_setprio 0
    v_mfma_f32_32x32x16_bf16 v[112:127], v[208:211], v[228:231], v[112:127]
    ds_read_b64_tr_b16 v[208:209], v8 offset:36864
    ds_read_b64_tr_b16 v[210:211], v8 offset:39936
    ds_read_b64_tr_b16 v[212:213], v7 offset:37376
    ds_read_b64_tr_b16 v[214:215], v7 offset:40448
    s_setprio 1
    v_rcp_f16_sdwa v200, v200 dst_sel:WORD_0 dst_unused:UNUSED_PRESERVE src0_sel:WORD_0
    v_rcp_f16_sdwa v201, v201 dst_sel:WORD_0 dst_unused:UNUSED_PRESERVE src0_sel:WORD_0
    s_setprio 0
    v_mfma_f32_32x32x16_bf16 v[96:111], v[224:227], v[220:223], v[96:111]
    s_setprio 1
    v_rcp_f16_sdwa v200, v200 dst_sel:WORD_1 dst_unused:UNUSED_PRESERVE src0_sel:WORD_1
    v_rcp_f16_sdwa v201, v201 dst_sel:WORD_1 dst_unused:UNUSED_PRESERVE src0_sel:WORD_1
    s_setprio 0
    v_mfma_f32_32x32x16_bf16 v[128:143], v[216:219], v[228:231], v[128:143]
    s_setprio 1
    v_fma_mix_f32 v196, v196, v200, 0 op_sel:[0,0,0] op_sel_hi:[0,1,0]
    v_fma_mix_f32 v197, v197, v200, 0 op_sel:[0,1,0] op_sel_hi:[0,1,0]
    v_fma_mix_f32 v198, v198, v201, 0 op_sel:[0,0,0] op_sel_hi:[0,1,0]
    v_fma_mix_f32 v199, v199, v201, 0 op_sel:[0,1,0] op_sel_hi:[0,1,0]
    s_setprio 0
    v_mfma_f32_32x32x16_bf16 v[144:159], v[224:227], v[228:231], v[144:159]
    s_waitcnt lgkmcnt(11)
    s_setprio 1
    v_cvt_pk_bf16_f32 v204, v196, v197
    v_cvt_pk_bf16_f32 v205, v198, v199
    v_add_u32 v10, 128, v10
    v_add_u32 v11, 24576, v11
    v_add_u32 v4, 256, v4
    s_setprio 0
    v_mfma_f32_16x16x32_bf16 v[184:187], v[236:239], v[232:235], v[184:187]
    s_waitcnt lgkmcnt(9)
    v_mfma_f32_16x16x32_bf16 v[188:191], v[240:243], v[232:235], v[188:191]
    s_waitcnt lgkmcnt(7)
    v_mfma_f32_16x16x32_bf16 v[192:195], v[244:247], v[232:235], v[192:195]
    s_waitcnt lgkmcnt(4)
    v_mfma_f32_16x16x32_bf16 v[184:187], v[252:255], v[248:251], v[184:187]
    s_waitcnt lgkmcnt(2)
    v_mfma_f32_16x16x32_bf16 v[188:191], v[208:211], v[248:251], v[188:191]
    s_waitcnt lgkmcnt(0)
    v_mfma_f32_16x16x32_bf16 v[192:195], v[212:215], v[248:251], v[192:195]
    s_sub_u32 s61, s61, 1
    s_cmp_lg_u32 s61, 0
    s_waitcnt vmcnt(0) lgkmcnt(0)
    s_cbranch_scc1 L_Qloop
L_Qpost:
    s_barrier
    ds_write_b64 v5, v[204:205] offset:2048
    ds_read_b128 v[160:163], v6 offset:12544
    ds_read_b128 v[164:167], v6 offset:13568
    ds_read_b64_tr_b16 v[208:209], v1 offset:0
    ds_read_b64_tr_b16 v[210:211], v1 offset:3072
    ds_read_b128 v[212:215], v2 offset:0
    ds_read_b64_tr_b16 v[216:217], v1 offset:512
    ds_read_b64_tr_b16 v[218:219], v1 offset:3584
    ds_read_b128 v[220:223], v2 offset:4096
    ds_read_b64_tr_b16 v[224:225], v1 offset:1024
    ds_read_b64_tr_b16 v[226:227], v1 offset:4096
    ds_read_b128 v[228:231], v2 offset:8192
    ds_read_b64_tr_b16 v[232:233], v1 offset:6144
    ds_read_b64_tr_b16 v[234:235], v1 offset:9216
    ds_read_b128 v[236:239], v2 offset:1024
    ds_read_b64_tr_b16 v[240:241], v1 offset:6656
    ds_read_b64_tr_b16 v[242:243], v1 offset:9728
    ds_read_b128 v[244:247], v2 offset:5120
    ds_read_b64_tr_b16 v[248:249], v1 offset:7168
    ds_read_b64_tr_b16 v[250:251], v1 offset:10240
    ds_read_b128 v[252:255], v2 offset:9216
    s_waitcnt lgkmcnt(14)
    v_mfma_f32_32x32x16_bf16 v[16:31], v[208:211], v[212:215], v[16:31]
    s_waitcnt lgkmcnt(13)
    v_mfma_f32_32x32x16_bf16 v[32:47], v[216:219], v[212:215], v[32:47]
    s_waitcnt lgkmcnt(12)
    v_mfma_f32_32x32x16_bf16 v[64:79], v[208:211], v[220:223], v[64:79]
    v_mfma_f32_32x32x16_bf16 v[80:95], v[216:219], v[220:223], v[80:95]
    s_waitcnt lgkmcnt(10)
    s_add_u32 m0, s52, 73728
    s_nop 0
    buffer_load_dwordx4 v11, s[20:23], s46 offen lds
    v_mfma_f32_32x32x16_bf16 v[48:63], v[224:227], v[212:215], v[48:63]
    s_waitcnt lgkmcnt(9)
    s_add_u32 m0, s52, 74752
    s_nop 0
    buffer_load_dwordx4 v11, s[20:23], s47 offen lds
    v_mfma_f32_32x32x16_bf16 v[112:127], v[208:211], v[228:231], v[112:127]
    ds_read_b64_tr_b16 v[208:209], v1 offset:12288
    ds_read_b64_tr_b16 v[210:211], v1 offset:15360
    ds_read_b128 v[212:215], v2 offset:2048
    s_add_u32 m0, s52, 75776
    s_nop 0
    buffer_load_dwordx4 v11, s[20:23], s48 offen lds
    v_mfma_f32_32x32x16_bf16 v[96:111], v[224:227], v[220:223], v[96:111]
    s_add_u32 m0, s52, 76800
    s_nop 0
    buffer_load_dwordx4 v11, s[20:23], s49 offen lds
    v_mfma_f32_32x32x16_bf16 v[128:143], v[216:219], v[228:231], v[128:143]
    ds_read_b64_tr_b16 v[216:217], v1 offset:12800
    ds_read_b64_tr_b16 v[218:219], v1 offset:15872
    ds_read_b128 v[220:223], v2 offset:6144
    s_add_u32 m0, s52, 77824
    s_nop 0
    buffer_load_dwordx4 v11, s[20:23], s50 offen lds
    v_mfma_f32_32x32x16_bf16 v[144:159], v[224:227], v[228:231], v[144:159]
    s_waitcnt lgkmcnt(12)
    ds_read_b64_tr_b16 v[224:225], v1 offset:13312
    ds_read_b64_tr_b16 v[226:227], v1 offset:16384
    ds_read_b128 v[228:231], v2 offset:10240
    s_add_u32 m0, s52, 78848
    s_nop 0
    buffer_load_dwordx4 v11, s[20:23], s51 offen lds
    v_mfma_f32_32x32x16_bf16 v[16:31], v[232:235], v[236:239], v[16:31]
    s_waitcnt lgkmcnt(13)
    s_add_u32 m0, s52, 0
    s_nop 0
    buffer_load_dwordx4 v160, s[8:11], s54 offen lds
    v_mfma_f32_32x32x16_bf16 v[32:47], v[240:243], v[236:239], v[32:47]
    s_waitcnt lgkmcnt(12)
    s_add_u32 m0, s52, 1024
    s_nop 0
    buffer_load_dwordx4 v161, s[8:11], s54 offen lds
    v_mfma_f32_32x32x16_bf16 v[64:79], v[232:235], v[244:247], v[64:79]
    s_add_u32 m0, s52, 2048
    s_nop 0
    buffer_load_dwordx4 v162, s[8:11], s54 offen lds
    v_mfma_f32_32x32x16_bf16 v[80:95], v[240:243], v[244:247], v[80:95]
    s_waitcnt lgkmcnt(10)
    v_mfma_f32_32x32x16_bf16 v[48:63], v[248:251], v[236:239], v[48:63]
    s_waitcnt lgkmcnt(9)
    v_mfma_f32_32x32x16_bf16 v[112:127], v[232:235], v[252:255], v[112:127]
    ds_read_b64_tr_b16 v[232:233], v1 offset:18432
    ds_read_b64_tr_b16 v[234:235], v1 offset:21504
    ds_read_b128 v[236:239], v2 offset:3072
    v_mfma_f32_32x32x16_bf16 v[96:111], v[248:251], v[244:247], v[96:111]
    v_mfma_f32_32x32x16_bf16 v[128:143], v[240:243], v[252:255], v[128:143]
    ds_read_b64_tr_b16 v[240:241], v1 offset:18944
    ds_read_b64_tr_b16 v[242:243], v1 offset:22016
    ds_read_b128 v[244:247], v2 offset:7168
    v_mfma_f32_32x32x16_bf16 v[144:159], v[248:251], v[252:255], v[144:159]
    s_waitcnt lgkmcnt(12)
    ds_read_b64_tr_b16 v[248:249], v1 offset:19456
    ds_read_b64_tr_b16 v[250:251], v1 offset:22528
    ds_read_b128 v[252:255], v2 offset:11264
    v_mfma_f32_32x32x16_bf16 v[16:31], v[208:211], v[212:215], v[16:31]
    s_waitcnt lgkmcnt(13)
    s_add_u32 m0, s52, 3072
    s_nop 0
    buffer_load_dwordx4 v163, s[8:11], s54 offen lds
    v_mfma_f32_32x32x16_bf16 v[32:47], v[216:219], v[212:215], v[32:47]
    s_waitcnt lgkmcnt(12)
    s_add_u32 m0, s52, 4096
    s_nop 0
    buffer_load_dwordx4 v164, s[8:11], s54 offen lds
    v_mfma_f32_32x32x16_bf16 v[64:79], v[208:211], v[220:223], v[64:79]
    s_add_u32 m0, s52, 5120
    s_nop 0
    buffer_load_dwordx4 v165, s[8:11], s54 offen lds
    v_mfma_f32_32x32x16_bf16 v[80:95], v[216:219], v[220:223], v[80:95]
    s_waitcnt lgkmcnt(10)
    s_add_u32 m0, s52, 24576
    s_nop 0
    buffer_load_dwordx4 v160, s[8:11], s55 offen lds
    v_mfma_f32_32x32x16_bf16 v[48:63], v[224:227], v[212:215], v[48:63]
    s_waitcnt lgkmcnt(9)
    s_add_u32 m0, s52, 25600
    s_nop 0
    buffer_load_dwordx4 v161, s[8:11], s55 offen lds
    v_mfma_f32_32x32x16_bf16 v[112:127], v[208:211], v[228:231], v[112:127]
    ds_read_b128 v[208:211], v6 offset:0
    ds_read_b64_tr_b16 v[212:213], v7 offset:0
    ds_read_b64_tr_b16 v[214:215], v7 offset:3072
    s_add_u32 m0, s52, 26624
    s_nop 0
    buffer_load_dwordx4 v162, s[8:11], s55 offen lds
    v_mfma_f32_32x32x16_bf16 v[96:111], v[224:227], v[220:223], v[96:111]
    s_add_u32 m0, s52, 27648
    s_nop 0
    buffer_load_dwordx4 v163, s[8:11], s55 offen lds
    v_mfma_f32_32x32x16_bf16 v[128:143], v[216:219], v[228:231], v[128:143]
    ds_read_b64_tr_b16 v[216:217], v8 offset:0
    ds_read_b64_tr_b16 v[218:219], v8 offset:3072
    ds_read_b64_tr_b16 v[220:221], v7 offset:512
    ds_read_b64_tr_b16 v[222:223], v7 offset:3584
    s_add_u32 m0, s52, 28672
    s_nop 0
    buffer_load_dwordx4 v164, s[8:11], s55 offen lds
    v_mfma_f32_32x32x16_bf16 v[144:159], v[224:227], v[228:231], v[144:159]
    s_waitcnt lgkmcnt(13)
    ds_read_b128 v[224:227], v6 offset:1024
    ds_read_b64_tr_b16 v[228:229], v7 offset:12288
    ds_read_b64_tr_b16 v[230:231], v7 offset:15360
    s_add_u32 m0, s52, 29696
    s_nop 0
    buffer_load_dwordx4 v165, s[8:11], s55 offen lds
    v_mfma_f32_32x32x16_bf16 v[16:31], v[232:235], v[236:239], v[16:31]
    s_waitcnt lgkmcnt(14)
    v_mfma_f32_32x32x16_bf16 v[32:47], v[240:243], v[236:239], v[32:47]
    s_waitcnt lgkmcnt(13)
    buffer_load_dwordx2 v[204:205], v206, s[8:11], s53 offen offset:0
    buffer_load_dwordx2 v[4:5], v206, s[8:11], s53 offen offset:32
    buffer_load_dwordx2 v[10:11], v206, s[8:11], s53 offen offset:64
    v_mfma_f32_32x32x16_bf16 v[64:79], v[232:235], v[244:247], v[64:79]
    v_mfma_f32_32x32x16_bf16 v[80:95], v[240:243], v[244:247], v[80:95]
    s_waitcnt lgkmcnt(11)
    v_mfma_f32_32x32x16_bf16 v[48:63], v[248:251], v[236:239], v[48:63]
    s_waitcnt lgkmcnt(10)
    v_mfma_f32_32x32x16_bf16 v[112:127], v[232:235], v[252:255], v[112:127]
    ds_read_b64_tr_b16 v[232:233], v8 offset:12288
    ds_read_b64_tr_b16 v[234:235], v8 offset:15360
    ds_read_b64_tr_b16 v[236:237], v7 offset:12800
    ds_read_b64_tr_b16 v[238:239], v7 offset:15872
    v_mfma_f32_32x32x16_bf16 v[96:111], v[248:251], v[244:247], v[96:111]
    v_mfma_f32_32x32x16_bf16 v[128:143], v[240:243], v[252:255], v[128:143]
    v_mfma_f32_32x32x16_bf16 v[144:159], v[248:251], v[252:255], v[144:159]
    s_waitcnt lgkmcnt(11)
    v_mfma_f32_16x16x32_bf16 v[184:187], v[212:215], v[208:211], v[184:187]
    s_waitcnt lgkmcnt(9)
    v_mfma_f32_16x16x32_bf16 v[188:191], v[216:219], v[208:211], v[188:191]
    s_waitcnt lgkmcnt(7)
    v_mfma_f32_16x16x32_bf16 v[192:195], v[220:223], v[208:211], v[192:195]
    s_waitcnt lgkmcnt(4)
    v_mfma_f32_16x16x32_bf16 v[184:187], v[228:231], v[224:227], v[184:187]
    s_waitcnt lgkmcnt(2)
    v_mfma_f32_16x16x32_bf16 v[188:191], v[232:235], v[224:227], v[188:191]
    s_waitcnt lgkmcnt(0)
    v_mfma_f32_16x16x32_bf16 v[192:195], v[236:239], v[224:227], v[192:195]
    s_waitcnt vmcnt(15) lgkmcnt(0)
    s_barrier
    ds_read_b128 v[160:163], v2 offset:24576
    ds_read_b64_tr_b16 v[208:209], v1 offset:24576
    ds_read_b64_tr_b16 v[210:211], v1 offset:27648
    ds_read_b64_tr_b16 v[212:213], v1 offset:25088
    ds_read_b64_tr_b16 v[214:215], v1 offset:28160
    ds_read_b64_tr_b16 v[216:217], v1 offset:25600
    ds_read_b64_tr_b16 v[218:219], v1 offset:28672
    ds_read_b128 v[164:167], v2 offset:25600
    ds_read_b64_tr_b16 v[220:221], v1 offset:30720
    ds_read_b64_tr_b16 v[222:223], v1 offset:33792
    ds_read_b64_tr_b16 v[224:225], v1 offset:31232
    ds_read_b64_tr_b16 v[226:227], v1 offset:34304
    s_waitcnt lgkmcnt(9)
    v_mfma_f32_32x32x16_bf16 v[16:31], v[208:211], v[160:163], v[16:31]
    s_waitcnt lgkmcnt(7)
    ds_read_b128 v[176:179], v6 offset:2048
    ds_read_b64_tr_b16 v[180:181], v7 offset:24576
    ds_read_b64_tr_b16 v[182:183], v7 offset:27648
    ds_read_b64_tr_b16 v[228:229], v1 offset:31744
    ds_read_b64_tr_b16 v[230:231], v1 offset:34816
    v_mfma_f32_32x32x16_bf16 v[32:47], v[212:215], v[160:163], v[32:47]
    s_waitcnt lgkmcnt(10)
    ds_read_b64_tr_b16 v[196:197], v8 offset:24576
    ds_read_b64_tr_b16 v[198:199], v8 offset:27648
    ds_read_b64_tr_b16 v[200:201], v7 offset:25088
    ds_read_b64_tr_b16 v[202:203], v7 offset:28160
    v_mfma_f32_32x32x16_bf16 v[48:63], v[216:219], v[160:163], v[48:63]
    s_waitcnt lgkmcnt(11)
    ds_read_b128 v[168:171], v2 offset:26624
    ds_read_b64_tr_b16 v[232:233], v1 offset:36864
    ds_read_b64_tr_b16 v[234:235], v1 offset:39936
    ds_read_b64_tr_b16 v[236:237], v1 offset:37376
    ds_read_b64_tr_b16 v[238:239], v1 offset:40448
    v_mfma_f32_32x32x16_bf16 v[16:31], v[220:223], v[164:167], v[16:31]
    s_waitcnt lgkmcnt(11)
    ds_read_b64_tr_b16 v[240:241], v1 offset:37888
    ds_read_b64_tr_b16 v[242:243], v1 offset:40960
    ds_read_b128 v[172:175], v2 offset:27648
    ds_read_b128 v[160:163], v2 offset:28672
    v_mfma_f32_16x16x32_bf16 v[184:187], v[180:183], v[176:179], v[184:187]
    s_waitcnt lgkmcnt(11)
    v_mfma_f32_16x16x32_bf16 v[188:191], v[196:199], v[176:179], v[188:191]
    s_waitcnt lgkmcnt(9)
    v_mfma_f32_16x16x32_bf16 v[192:195], v[200:203], v[176:179], v[192:195]
    ds_read_b128 v[176:179], v6 offset:3072
    ds_read_b64_tr_b16 v[180:181], v7 offset:36864
    ds_read_b64_tr_b16 v[182:183], v7 offset:39936
    ds_read_b64_tr_b16 v[196:197], v8 offset:36864
    v_mfma_f32_32x32x16_bf16 v[32:47], v[224:227], v[164:167], v[32:47]
    ds_read_b64_tr_b16 v[198:199], v8 offset:39936
    ds_read_b64_tr_b16 v[200:201], v7 offset:37376
    ds_read_b64_tr_b16 v[202:203], v7 offset:40448
    ds_read_b64_tr_b16 v[244:245], v1 offset:43008
    ds_read_b64_tr_b16 v[246:247], v1 offset:46080
    v_mfma_f32_32x32x16_bf16 v[48:63], v[228:231], v[164:167], v[48:63]
    s_waitcnt lgkmcnt(14)
    ds_read_b64_tr_b16 v[248:249], v1 offset:43520
    ds_read_b64_tr_b16 v[250:251], v1 offset:46592
    ds_read_b64_tr_b16 v[252:253], v1 offset:44032
    ds_read_b64_tr_b16 v[254:255], v1 offset:47104
    ds_read_b128 v[164:167], v2 offset:29696
    v_mfma_f32_32x32x16_bf16 v[16:31], v[232:235], v[168:171], v[16:31]
    s_waitcnt lgkmcnt(11)
    v_mfma_f32_16x16x32_bf16 v[184:187], v[180:183], v[176:179], v[184:187]
    s_waitcnt lgkmcnt(9)
    v_mfma_f32_16x16x32_bf16 v[188:191], v[196:199], v[176:179], v[188:191]
    s_waitcnt lgkmcnt(7)
    v_mfma_f32_16x16x32_bf16 v[192:195], v[200:203], v[176:179], v[192:195]
    ds_read_b128 v[176:179], v207 offset:0
    ds_read_b128 v[180:183], v207 offset:64
    ds_read_b128 v[196:199], v207 offset:128
    v_mfma_f32_32x32x16_bf16 v[32:47], v[236:239], v[168:171], v[32:47]
    v_mfma_f32_32x32x16_bf16 v[48:63], v[240:243], v[168:171], v[48:63]
    s_waitcnt lgkmcnt(8)
    ds_read_b128 v[168:171], v2 offset:30720
    s_waitcnt vmcnt(2)
    v_lshlrev_b32 v200, 16, v204
    v_and_b32 v201, 0xffff0000, v204
    v_lshlrev_b32 v202, 16, v205
    v_and_b32 v203, 0xffff0000, v205
    s_waitcnt lgkmcnt(3)
    v_fmac_f32 v200, v184, v176
    v_fmac_f32 v201, v185, v177
    v_mfma_f32_32x32x16_bf16 v[16:31], v[244:247], v[172:175], v[16:31]
    v_fmac_f32 v202, v186, v178
    v_fmac_f32 v203, v187, v179
    v_cvt_pk_bf16_f32 v204, v200, v201
    v_cvt_pk_bf16_f32 v205, v202, v203
    s_waitcnt vmcnt(1)
    v_lshlrev_b32 v200, 16, v4
    v_and_b32 v201, 0xffff0000, v4
    v_mfma_f32_32x32x16_bf16 v[32:47], v[248:251], v[172:175], v[32:47]
    v_lshlrev_b32 v202, 16, v5
    v_and_b32 v203, 0xffff0000, v5
    s_waitcnt lgkmcnt(2)
    v_fmac_f32 v200, v188, v180
    v_fmac_f32 v201, v189, v181
    v_fmac_f32 v202, v190, v182
    v_fmac_f32 v203, v191, v183
    v_mfma_f32_32x32x16_bf16 v[48:63], v[252:255], v[172:175], v[48:63]
    ds_read_b128 v[172:175], v2 offset:31744
    v_cvt_pk_bf16_f32 v4, v200, v201
    v_cvt_pk_bf16_f32 v5, v202, v203
    s_waitcnt vmcnt(0)
    v_lshlrev_b32 v200, 16, v10
    v_and_b32 v201, 0xffff0000, v10
    v_lshlrev_b32 v202, 16, v11
    v_and_b32 v203, 0xffff0000, v11
    s_waitcnt lgkmcnt(2)
    v_fmac_f32 v200, v192, v196
    v_fmac_f32 v201, v193, v197
    v_fmac_f32 v202, v194, v198
    v_fmac_f32 v203, v195, v199
    v_cvt_pk_bf16_f32 v10, v200, v201
    v_cvt_pk_bf16_f32 v11, v202, v203
    buffer_store_dwordx2 v[204:205], v206, s[12:15], s53 offen offset:0 nt
    buffer_store_dwordx2 v[4:5], v206, s[12:15], s53 offen offset:32 nt
    buffer_store_dwordx2 v[10:11], v206, s[12:15], s53 offen offset:64 nt
    ds_read_b128 v[184:187], v9 offset:0
    ds_read_b128 v[188:191], v9 offset:16
    ds_read_b128 v[192:195], v9 offset:64
    ds_read_b128 v[196:199], v9 offset:80
    ds_read_b128 v[200:203], v6 offset:10496
    ds_read_b128 v[204:207], v6 offset:11520
    s_waitcnt vmcnt(3)
    s_barrier
    ds_read_b128 v[176:179], v12 offset:0
    ds_read_b128 v[180:183], v13 offset:0
    v_mfma_f32_32x32x16_bf16 v[64:79], v[208:211], v[160:163], v[64:79]
    s_waitcnt lgkmcnt(4)
    v_mul_f32 v16, v16, v184
    v_mul_f32 v17, v17, v185
    v_mul_f32 v18, v18, v186
    v_mul_f32 v19, v19, v187
    v_mul_f32 v20, v20, v188
    v_mul_f32 v21, v21, v189
    v_mfma_f32_32x32x16_bf16 v[80:95], v[212:215], v[160:163], v[80:95]
    v_mul_f32 v22, v22, v190
    v_mul_f32 v23, v23, v191
    v_mul_f32 v24, v24, v192
    v_mul_f32 v25, v25, v193
    v_mul_f32 v26, v26, v194
    v_mul_f32 v27, v27, v195
    v_mfma_f32_32x32x16_bf16 v[96:111], v[216:219], v[160:163], v[96:111]
    ds_read_b128 v[160:163], v2 offset:32768
    v_mul_f32 v28, v28, v196
    v_mul_f32 v29, v29, v197
    v_mul_f32 v30, v30, v198
    v_mul_f32 v31, v31, v199
    v_mfma_f32_32x32x16_bf16 v[64:79], v[220:223], v[164:167], v[64:79]
    ds_read_b128 v[184:187], v9 offset:128
    ds_read_b128 v[188:191], v9 offset:144
    ds_read_b128 v[192:195], v9 offset:192
    ds_read_b128 v[196:199], v9 offset:208
    s_waitcnt lgkmcnt(6)
    v_mfma_f32_32x32x16_bf16 v[16:31], v[200:203], v[176:179], v[16:31]
    s_waitcnt lgkmcnt(5)
    v_mfma_f32_32x32x16_bf16 v[16:31], v[204:207], v[180:183], v[16:31]
    ds_read_b128 v[176:179], v14 offset:0
    ds_read_b128 v[180:183], v15 offset:0
    v_mfma_f32_32x32x16_bf16 v[80:95], v[224:227], v[164:167], v[80:95]
    s_waitcnt lgkmcnt(2)
    v_mul_f32 v32, v32, v184
    v_mul_f32 v33, v33, v185
    v_mul_f32 v34, v34, v186
    v_mul_f32 v35, v35, v187
    v_mul_f32 v36, v36, v188
    v_mul_f32 v37, v37, v189
    v_mfma_f32_32x32x16_bf16 v[96:111], v[228:231], v[164:167], v[96:111]
    ds_read_b128 v[164:167], v2 offset:33792
    v_mul_f32 v38, v38, v190
    v_mul_f32 v39, v39, v191
    v_mul_f32 v40, v40, v192
    v_mul_f32 v41, v41, v193
    v_mul_f32 v42, v42, v194
    v_mul_f32 v43, v43, v195
    v_mfma_f32_32x32x16_bf16 v[64:79], v[232:235], v[168:171], v[64:79]
    v_mul_f32 v44, v44, v196
    v_mul_f32 v45, v45, v197
    v_mul_f32 v46, v46, v198
    v_mul_f32 v47, v47, v199
    v_cvt_pk_bf16_f32 v16, v16, v17
    v_cvt_pk_bf16_f32 v17, v18, v19
    v_mfma_f32_32x32x16_bf16 v[80:95], v[236:239], v[168:171], v[80:95]
    ds_read_b128 v[184:187], v9 offset:256
    ds_read_b128 v[188:191], v9 offset:272
    ds_read_b128 v[192:195], v9 offset:320
    ds_read_b128 v[196:199], v9 offset:336
    v_cvt_pk_bf16_f32 v18, v20, v21
    v_cvt_pk_bf16_f32 v19, v22, v23
    v_cvt_pk_bf16_f32 v20, v24, v25
    v_cvt_pk_bf16_f32 v21, v26, v27
    v_cvt_pk_bf16_f32 v22, v28, v29
    v_cvt_pk_bf16_f32 v23, v30, v31
    s_waitcnt lgkmcnt(6)
    v_mfma_f32_32x32x16_bf16 v[32:47], v[200:203], v[176:179], v[32:47]
    s_waitcnt lgkmcnt(5)
    ds_write_b128 v12, v[16:19] offset:0
    v_mfma_f32_32x32x16_bf16 v[32:47], v[204:207], v[180:183], v[32:47]
    ds_write_b128 v13, v[20:23] offset:0
    ds_read_b128 v[176:179], v12 offset:128
    ds_read_b128 v[180:183], v13 offset:128
    v_mfma_f32_32x32x16_bf16 v[96:111], v[240:243], v[168:171], v[96:111]
    s_waitcnt lgkmcnt(4)
    ds_read_b128 v[168:171], v2 offset:34816
    v_mul_f32 v48, v48, v184
    v_mul_f32 v49, v49, v185
    v_mul_f32 v50, v50, v186
    v_mul_f32 v51, v51, v187
    v_mul_f32 v52, v52, v188
    v_mul_f32 v53, v53, v189
    v_mfma_f32_32x32x16_bf16 v[64:79], v[244:247], v[172:175], v[64:79]
    v_mul_f32 v54, v54, v190
    v_mul_f32 v55, v55, v191
    v_mul_f32 v56, v56, v192
    v_mul_f32 v57, v57, v193
    v_mul_f32 v58, v58, v194
    v_mul_f32 v59, v59, v195
    v_mfma_f32_32x32x16_bf16 v[80:95], v[248:251], v[172:175], v[80:95]
    v_mul_f32 v60, v60, v196
    v_mul_f32 v61, v61, v197
    v_mul_f32 v62, v62, v198
    v_mul_f32 v63, v63, v199
    v_cvt_pk_bf16_f32 v32, v32, v33
    v_cvt_pk_bf16_f32 v33, v34, v35
    v_mfma_f32_32x32x16_bf16 v[96:111], v[252:255], v[172:175], v[96:111]
    ds_read_b128 v[172:175], v2 offset:35840
    ds_read_b128 v[184:187], v9 offset:0
    ds_read_b128 v[188:191], v9 offset:16
    ds_read_b128 v[192:195], v9 offset:64
    ds_read_b128 v[196:199], v9 offset:80
    v_cvt_pk_bf16_f32 v34, v36, v37
    v_cvt_pk_bf16_f32 v35, v38, v39
    v_cvt_pk_bf16_f32 v36, v40, v41
    v_cvt_pk_bf16_f32 v37, v42, v43
    v_cvt_pk_bf16_f32 v38, v44, v45
    v_cvt_pk_bf16_f32 v39, v46, v47
    s_waitcnt lgkmcnt(7)
    v_mfma_f32_32x32x16_bf16 v[48:63], v[200:203], v[176:179], v[48:63]
    s_waitcnt lgkmcnt(6)
    ds_write_b128 v14, v[32:35] offset:0
    v_mfma_f32_32x32x16_bf16 v[48:63], v[204:207], v[180:183], v[48:63]
    ds_write_b128 v15, v[36:39] offset:0
    ds_read_b128 v[176:179], v12 offset:24576
    ds_read_b128 v[180:183], v13 offset:24576
    v_mfma_f32_32x32x16_bf16 v[112:127], v[208:211], v[160:163], v[112:127]
    s_waitcnt lgkmcnt(4)
    v_mul_f32 v64, v64, v184
    v_mul_f32 v65, v65, v185
    v_mul_f32 v66, v66, v186
    v_mul_f32 v67, v67, v187
    v_mul_f32 v68, v68, v188
    v_mul_f32 v69, v69, v189
    v_mfma_f32_32x32x16_bf16 v[128:143], v[212:215], v[160:163], v[128:143]
    v_mul_f32 v70, v70, v190
    v_mul_f32 v71, v71, v191
    v_mul_f32 v72, v72, v192
    v_mul_f32 v73, v73, v193
    v_mul_f32 v74, v74, v194
    v_mul_f32 v75, v75, v195
    v_mfma_f32_32x32x16_bf16 v[144:159], v[216:219], v[160:163], v[144:159]
    v_mul_f32 v76, v76, v196
    v_mul_f32 v77, v77, v197
    v_mul_f32 v78, v78, v198
    v_mul_f32 v79, v79, v199
    v_cvt_pk_bf16_f32 v48, v48, v49
    v_cvt_pk_bf16_f32 v49, v50, v51
    v_mfma_f32_32x32x16_bf16 v[112:127], v[220:223], v[164:167], v[112:127]
    ds_read_b128 v[184:187], v9 offset:128
    ds_read_b128 v[188:191], v9 offset:144
    ds_read_b128 v[192:195], v9 offset:192
    ds_read_b128 v[196:199], v9 offset:208
    v_cvt_pk_bf16_f32 v50, v52, v53
    v_cvt_pk_bf16_f32 v51, v54, v55
    v_cvt_pk_bf16_f32 v52, v56, v57
    v_cvt_pk_bf16_f32 v53, v58, v59
    v_cvt_pk_bf16_f32 v54, v60, v61
    v_cvt_pk_bf16_f32 v55, v62, v63
    s_waitcnt lgkmcnt(5)
    v_mfma_f32_32x32x16_bf16 v[64:79], v[200:203], v[176:179], v[64:79]
    s_waitcnt lgkmcnt(4)
    ds_write_b128 v12, v[48:51] offset:128
    v_mfma_f32_32x32x16_bf16 v[64:79], v[204:207], v[180:183], v[64:79]
    ds_write_b128 v13, v[52:55] offset:128
    ds_read_b128 v[176:179], v14 offset:24576
    ds_read_b128 v[180:183], v15 offset:24576
    v_mfma_f32_32x32x16_bf16 v[128:143], v[224:227], v[164:167], v[128:143]
    s_waitcnt lgkmcnt(4)
    v_mul_f32 v80, v80, v184
    v_mul_f32 v81, v81, v185
    v_mul_f32 v82, v82, v186
    v_mul_f32 v83, v83, v187
    v_mul_f32 v84, v84, v188
    v_mul_f32 v85, v85, v189
    v_mfma_f32_32x32x16_bf16 v[144:159], v[228:231], v[164:167], v[144:159]
    s_waitcnt lgkmcnt(0)
    s_barrier
    v_mul_f32 v86, v86, v190
    v_mul_f32 v87, v87, v191
    v_mul_f32 v88, v88, v192
    v_mul_f32 v89, v89, v193
    v_mul_f32 v90, v90, v194
    v_mul_f32 v91, v91, v195
    v_mfma_f32_32x32x16_bf16 v[112:127], v[232:235], v[168:171], v[112:127]
    v_mul_f32 v92, v92, v196
    v_mul_f32 v93, v93, v197
    v_mul_f32 v94, v94, v198
    v_mul_f32 v95, v95, v199
    v_cvt_pk_bf16_f32 v64, v64, v65
    v_cvt_pk_bf16_f32 v65, v66, v67
    v_mfma_f32_32x32x16_bf16 v[128:143], v[236:239], v[168:171], v[128:143]
    ds_read_b128 v[184:187], v9 offset:256
    ds_read_b128 v[188:191], v9 offset:272
    ds_read_b128 v[192:195], v9 offset:320
    ds_read_b128 v[196:199], v9 offset:336
    v_cvt_pk_bf16_f32 v66, v68, v69
    v_cvt_pk_bf16_f32 v67, v70, v71
    v_cvt_pk_bf16_f32 v68, v72, v73
    v_cvt_pk_bf16_f32 v69, v74, v75
    v_cvt_pk_bf16_f32 v70, v76, v77
    v_cvt_pk_bf16_f32 v71, v78, v79
    v_mfma_f32_32x32x16_bf16 v[80:95], v[200:203], v[176:179], v[80:95]
    ds_write_b128 v12, v[64:67] offset:24576
    v_mfma_f32_32x32x16_bf16 v[80:95], v[204:207], v[180:183], v[80:95]
    ds_write_b128 v13, v[68:71] offset:24576
    ds_read_b128 v[176:179], v12 offset:24704
    ds_read_b128 v[180:183], v13 offset:24704
    v_mfma_f32_32x32x16_bf16 v[144:159], v[240:243], v[168:171], v[144:159]
    s_waitcnt lgkmcnt(4)
    v_mul_f32 v96, v96, v184
    v_mul_f32 v97, v97, v185
    v_mul_f32 v98, v98, v186
    v_mul_f32 v99, v99, v187
    v_mul_f32 v100, v100, v188
    v_mul_f32 v101, v101, v189
    v_mfma_f32_32x32x16_bf16 v[112:127], v[244:247], v[172:175], v[112:127]
    v_mul_f32 v102, v102, v190
    v_mul_f32 v103, v103, v191
    v_mul_f32 v104, v104, v192
    v_mul_f32 v105, v105, v193
    v_mul_f32 v106, v106, v194
    v_mul_f32 v107, v107, v195
    v_mfma_f32_32x32x16_bf16 v[128:143], v[248:251], v[172:175], v[128:143]
    v_mul_f32 v108, v108, v196
    v_mul_f32 v109, v109, v197
    v_mul_f32 v110, v110, v198
    v_mul_f32 v111, v111, v199
    v_cvt_pk_bf16_f32 v80, v80, v81
    v_cvt_pk_bf16_f32 v81, v82, v83
    v_mfma_f32_32x32x16_bf16 v[144:159], v[252:255], v[172:175], v[144:159]
    ds_read_b128 v[184:187], v9 offset:0
    ds_read_b128 v[188:191], v9 offset:16
    ds_read_b128 v[192:195], v9 offset:64
    ds_read_b128 v[196:199], v9 offset:80
    v_cvt_pk_bf16_f32 v82, v84, v85
    v_cvt_pk_bf16_f32 v83, v86, v87
    v_cvt_pk_bf16_f32 v84, v88, v89
    v_cvt_pk_bf16_f32 v85, v90, v91
    v_cvt_pk_bf16_f32 v86, v92, v93
    v_cvt_pk_bf16_f32 v87, v94, v95
    s_waitcnt lgkmcnt(5)
    v_mfma_f32_32x32x16_bf16 v[96:111], v[200:203], v[176:179], v[96:111]
    s_waitcnt lgkmcnt(4)
    ds_write_b128 v14, v[80:83] offset:24576
    v_mfma_f32_32x32x16_bf16 v[96:111], v[204:207], v[180:183], v[96:111]
    ds_write_b128 v15, v[84:87] offset:24576
    ds_read_b128 v[176:179], v12 offset:49152
    ds_read_b128 v[180:183], v13 offset:49152
    s_waitcnt lgkmcnt(4)
    v_mul_f32 v112, v112, v184
    v_mul_f32 v113, v113, v185
    v_mul_f32 v114, v114, v186
    v_mul_f32 v115, v115, v187
    v_mul_f32 v116, v116, v188
    v_mul_f32 v117, v117, v189
    v_mul_f32 v118, v118, v190
    v_mul_f32 v119, v119, v191
    v_mul_f32 v120, v120, v192
    v_mul_f32 v121, v121, v193
    v_mul_f32 v122, v122, v194
    v_mul_f32 v123, v123, v195
    v_mul_f32 v124, v124, v196
    v_mul_f32 v125, v125, v197
    v_mul_f32 v126, v126, v198
    v_mul_f32 v127, v127, v199
    v_cvt_pk_bf16_f32 v96, v96, v97
    v_cvt_pk_bf16_f32 v97, v98, v99
    ds_read_b128 v[184:187], v9 offset:128
    ds_read_b128 v[188:191], v9 offset:144
    ds_read_b128 v[192:195], v9 offset:192
    ds_read_b128 v[196:199], v9 offset:208
    v_cvt_pk_bf16_f32 v98, v100, v101
    v_cvt_pk_bf16_f32 v99, v102, v103
    v_cvt_pk_bf16_f32 v100, v104, v105
    v_cvt_pk_bf16_f32 v101, v106, v107
    v_cvt_pk_bf16_f32 v102, v108, v109
    v_cvt_pk_bf16_f32 v103, v110, v111
    s_waitcnt lgkmcnt(5)
    v_mfma_f32_32x32x16_bf16 v[112:127], v[200:203], v[176:179], v[112:127]
    s_waitcnt lgkmcnt(4)
    ds_write_b128 v12, v[96:99] offset:24704
    v_mfma_f32_32x32x16_bf16 v[112:127], v[204:207], v[180:183], v[112:127]
    ds_write_b128 v13, v[100:103] offset:24704
    ds_read_b128 v[176:179], v14 offset:49152
    ds_read_b128 v[180:183], v15 offset:49152
    s_waitcnt lgkmcnt(4)
    v_mul_f32 v128, v128, v184
    v_mul_f32 v129, v129, v185
    v_mul_f32 v130, v130, v186
    v_mul_f32 v131, v131, v187
    v_mul_f32 v132, v132, v188
    v_mul_f32 v133, v133, v189
    s_waitcnt lgkmcnt(0)
    s_barrier
    v_mul_f32 v134, v134, v190
    v_mul_f32 v135, v135, v191
    v_mul_f32 v136, v136, v192
    v_mul_f32 v137, v137, v193
    v_mul_f32 v138, v138, v194
    v_mul_f32 v139, v139, v195
    v_mul_f32 v140, v140, v196
    v_mul_f32 v141, v141, v197
    v_mul_f32 v142, v142, v198
    v_mul_f32 v143, v143, v199
    v_cvt_pk_bf16_f32 v112, v112, v113
    v_cvt_pk_bf16_f32 v113, v114, v115
    ds_read_b128 v[184:187], v9 offset:256
    ds_read_b128 v[188:191], v9 offset:272
    ds_read_b128 v[192:195], v9 offset:320
    ds_read_b128 v[196:199], v9 offset:336
    v_cvt_pk_bf16_f32 v114, v116, v117
    v_cvt_pk_bf16_f32 v115, v118, v119
    v_cvt_pk_bf16_f32 v116, v120, v121
    v_cvt_pk_bf16_f32 v117, v122, v123
    v_cvt_pk_bf16_f32 v118, v124, v125
    v_cvt_pk_bf16_f32 v119, v126, v127
    v_mfma_f32_32x32x16_bf16 v[128:143], v[200:203], v[176:179], v[128:143]
    ds_write_b128 v12, v[112:115] offset:49152
    v_mfma_f32_32x32x16_bf16 v[128:143], v[204:207], v[180:183], v[128:143]
    ds_write_b128 v13, v[116:119] offset:49152
    ds_read_b128 v[176:179], v12 offset:49280
    ds_read_b128 v[180:183], v13 offset:49280
    s_waitcnt lgkmcnt(4)
    v_mul_f32 v144, v144, v184
    v_mul_f32 v145, v145, v185
    v_mul_f32 v146, v146, v186
    v_mul_f32 v147, v147, v187
    v_mul_f32 v148, v148, v188
    v_mul_f32 v149, v149, v189
    v_mul_f32 v150, v150, v190
    v_mul_f32 v151, v151, v191
    v_mul_f32 v152, v152, v192
    v_mul_f32 v153, v153, v193
    v_mul_f32 v154, v154, v194
    v_mul_f32 v155, v155, v195
    v_mul_f32 v156, v156, v196
    v_mul_f32 v157, v157, v197
    v_mul_f32 v158, v158, v198
    v_mul_f32 v159, v159, v199
    v_cvt_pk_bf16_f32 v128, v128, v129
    v_cvt_pk_bf16_f32 v129, v130, v131
    v_cvt_pk_bf16_f32 v130, v132, v133
    v_cvt_pk_bf16_f32 v131, v134, v135
    v_cvt_pk_bf16_f32 v132, v136, v137
    v_cvt_pk_bf16_f32 v133, v138, v139
    v_cvt_pk_bf16_f32 v134, v140, v141
    v_cvt_pk_bf16_f32 v135, v142, v143
    s_waitcnt lgkmcnt(1)
    v_mfma_f32_32x32x16_bf16 v[144:159], v[200:203], v[176:179], v[144:159]
    s_waitcnt lgkmcnt(0)
    ds_write_b128 v14, v[128:131] offset:49152
    v_mfma_f32_32x32x16_bf16 v[144:159], v[204:207], v[180:183], v[144:159]
    ds_write_b128 v15, v[132:135] offset:49152
    s_nop 10
    v_cvt_pk_bf16_f32 v144, v144, v145
    v_cvt_pk_bf16_f32 v145, v146, v147
    v_cvt_pk_bf16_f32 v146, v148, v149
    v_cvt_pk_bf16_f32 v147, v150, v151
    v_cvt_pk_bf16_f32 v148, v152, v153
    v_cvt_pk_bf16_f32 v149, v154, v155
    v_cvt_pk_bf16_f32 v150, v156, v157
    v_cvt_pk_bf16_f32 v151, v158, v159
    ds_write_b128 v12, v[144:147] offset:49280
    ds_write_b128 v13, v[148:151] offset:49280
    s_waitcnt lgkmcnt(0)
    s_barrier
L_exit:
    s_endpgm
L_code_end:
.section .rodata,"a"
.p2align 6
.amdhsa_kernel standalone__modern_conv_block_convnext__vision_kernel
  .amdhsa_next_free_vgpr 256
  .amdhsa_next_free_sgpr 100
  .amdhsa_accum_offset 256
  .amdhsa_group_segment_fixed_size 0
  .amdhsa_kernarg_size 80
  .amdhsa_user_sgpr_count 2
  .amdhsa_user_sgpr_kernarg_segment_ptr 1
  .amdhsa_system_sgpr_workgroup_id_x 1
.end_amdhsa_kernel
```
